```python
import torch

def _softmax(x, axis=-1):
    return torch.softmax(x, dim=axis)
def _gelu(x):
    return torch.nn.functional.gelu(x, approximate="tanh")
def _silu(x):
    return torch.nn.functional.silu(x)
def _sigmoid(x):
    return torch.sigmoid(x)
def _layernorm(x, axis=-1, eps=1e-5):
    m = x.mean(dim=axis, keepdim=True)
    v = x.var(dim=axis, keepdim=True, unbiased=False)
    return (x - m) / torch.sqrt(v + eps)
def _scatter_add(tgt, idx, src, axis=0):
    return tgt.clone().index_add_(axis, idx, src)
def _segment_sum(src, seg, n):
    out = torch.zeros((n,) + src.shape[1:], dtype=src.dtype)
    return out.index_add_(0, seg, src)
def _pad(x, pw):
    flat = tuple(v for pair in reversed(pw) for v in pair)
    return torch.nn.functional.pad(x, flat)

kernel_name = 'parallel_sum__linear_attn_block__geglu_ffn__prompt'

def setup_inputs():

    _w = (lambda a: (lambda t: t.to(torch.bfloat16) if t.is_floating_point() else t)(torch.as_tensor(a)))
    def _A_setup():
        B, S, D = 1, 2048, 640
        return {
            "x": _w((lambda *s: torch.randn(*s, dtype=torch.bfloat16) * 0.05)(B, S, D)),
            "wqkv": _w((lambda *s: torch.randn(*s, dtype=torch.bfloat16) * 0.2)(D, 3 * D)),
            "wo": _w((lambda *s: torch.randn(*s, dtype=torch.bfloat16) * 0.2)(D, D)),
        }
    _A_in = _A_setup()

    def _B_setup():
        B, S, D, F = 1, 2048, 640, 1728
        return {
            "x": _w((lambda *s: torch.randn(*s, dtype=torch.bfloat16) * 0.05)(B, S, D)),
            "w_gate": _w((lambda *s: torch.randn(*s, dtype=torch.bfloat16) * 0.05)(D, F)),
            "w_up": _w((lambda *s: torch.randn(*s, dtype=torch.bfloat16) * 0.05)(D, F)),
            "w_down": _w((lambda *s: torch.randn(*s, dtype=torch.bfloat16) * 0.05)(F, D)),
        }
    _B_in = _B_setup()

    return {
        "A_x": _A_in["x"],
        "A_wqkv": _A_in["wqkv"],
        "A_wo": _A_in["wo"],
        "B_x": _B_in["x"],
        "B_w_gate": _B_in["w_gate"],
        "B_w_up": _B_in["w_up"],
        "B_w_down": _B_in["w_down"],
    }

def reference(A_x, A_wqkv, A_wo, B_x, B_w_gate, B_w_up, B_w_down):
    def _A_ref(x, wqkv, wo):
        B, S, D = x.shape
        H = 32; Dh = D // H
        qkv = (lambda x, *d: x.permute(*d))((x @ wqkv).reshape(B, S, 3, H, Dh), 2, 0, 3, 1, 4)
        q, k, v = qkv[0], qkv[1], qkv[2]
        phi = lambda t: torch.where(t > 0, t + 1, torch.exp(t)) + 1e-6
        pq, pk = phi(q), phi(k)
        kv = torch.einsum("bhsd,bhse->bhde", pk, v)
        z = torch.einsum("bhsd->bhd", pk)
        num = torch.einsum("bhqd,bhde->bhqe", pq, kv)
        den = torch.einsum("bhqd,bhd->bhq", pq, z)[..., None] + 1e-6
        o = num / den
        return (lambda x, *d: x.permute(*d))(o, 0, 2, 1, 3).reshape(B, S, D) @ wo

    def _B_ref(x, w_gate, w_up, w_down):
        return (_gelu(x @ w_gate) * (x @ w_up)) @ w_down

    x = A_x
    xn = _layernorm(x, axis=-1)
    return x + _A_ref(xn, A_wqkv, A_wo) + _B_ref(xn, B_w_gate, B_w_up, B_w_down)
```

```asm
; @launch grid=(256,1,1) block=(768,1,1) lds=163840
.amdgcn_target "amdgcn-amd-amdhsa--gfx950"
.text
.globl parallel_sum__linear_attn_block__geglu_ffn__prompt_kernel
.p2align 8
.type parallel_sum__linear_attn_block__geglu_ffn__prompt_kernel,@function
parallel_sum__linear_attn_block__geglu_ffn__prompt_kernel:
    s_cmp_ge_u32 s2, 256
    s_cbranch_scc1 K1_END
    s_load_dwordx16 s[4:19], s[0:1], 0
    s_load_dwordx4 s[20:23], s[0:1], 64
    v_lshrrev_b32 v1, 6, v0
    v_lshlrev_b32 v2, 7, v0
    v_readfirstlane_b32 s24, v1
    v_and_b32 v0, 63, v0
    s_getpc_b64 s[60:61]
K1_CPF0_PC:
    s_lshr_b32 s62, s2, 3
    s_lshr_b32 s63, s24, 3
    s_or_b32 s62, s62, s63
    s_cbranch_scc1 K1_CPF0_DONE
    v_min_u32 v2, K1_END-K1_CPF0_PC, v2
    v_mov_b32 v3, s61
    v_add_co_u32 v2, vcc, s60, v2
    s_nop 1
    v_addc_co_u32 v3, vcc, 0, v3, vcc
    global_load_dword v1, v[2:3], off
K1_CPF0_DONE:
    s_and_b32 s29, s2, 7
    s_lshr_b32 s30, s2, 3
    s_and_b32 s31, s29, 1
    s_lshl_b32 s31, s31, 2
    s_and_b32 s52, s30, 3
    s_add_u32 s25, s31, s52
    s_lshr_b32 s53, s30, 2
    s_lshr_b32 s54, s29, 1
    s_lshl_b32 s55, s54, 3
    s_cmp_eq_u32 s54, 3
    s_cselect_b32 s60, 1, 0
    s_sub_u32 s55, s55, s60
    s_add_u32 s27, s55, s53
    s_mul_i32 s61, s54, 5
    s_sub_u32 s61, s61, s60
    s_add_u32 s26, s61, s53
    s_cmp_ge_u32 s54, 2
    s_cselect_b32 s61, 4, 5
    s_add_u32 s62, s54, 18
    s_cmp_eq_u32 s53, s61
    s_cselect_b32 s26, s62, s26
    s_lshl_b32 s62, s54, 1
    s_add_u32 s62, s62, s53
    s_sub_u32 s62, s62, s61
    s_add_u32 s62, s62, 21
    s_cmp_gt_u32 s53, s61
    s_cselect_b32 s26, s62, s26
    s_cmp_ge_u32 s54, 2
    s_cselect_b32 s60, 7, 8
    s_waitcnt lgkmcnt(0)
    s_mov_b32 s32, s4
    s_and_b32 s33, s5, 0xffff
    s_mov_b32 s34, 2621440
    s_mov_b32 s35, 0x20000
    s_mov_b32 s48, s22
    s_and_b32 s49, s23, 0xffff
    s_mov_b32 s50, 14241792
    s_mov_b32 s51, 0x20000
    s_cmp_ge_u32 s53, s60
    s_cbranch_scc1 K1_PACK
    s_cmp_lt_u32 s24, 8
    s_cbranch_scc1 K1_COMP
    s_sub_u32 s60, s24, 8
    s_setprio 3
    v_lshrrev_b32 v4, 3, v0
    v_mul_u32_u24 v12, 1280, v4
    v_lshrrev_b32 v5, 4, v0
    v_and_b32 v6, 7, v0
    v_xor_b32 v7, v6, v5
    v_lshl_add_u32 v2, v7, 4, v12
    v_xor_b32 v7, 4, v7
    v_lshl_add_u32 v3, v7, 4, v12
    s_mov_b32 s74, 98304
    s_mul_i32 s76, s25, 327680
    s_mul_i32 s77, s60, 40960
    s_add_u32 s76, s76, s77
    s_lshl_b32 s75, s60, 12
    s_add_u32 s77, s75, 98304
    s_add_u32 m0, s75, 0
    s_add_u32 s81, s76, 0
    buffer_load_dwordx4 v2, s[32:35], s81 offen lds
    s_add_u32 m0, s75, 1024
    s_add_u32 s81, s76, 10240
    buffer_load_dwordx4 v3, s[32:35], s81 offen lds
    s_add_u32 m0, s75, 2048
    s_add_u32 s81, s76, 20480
    buffer_load_dwordx4 v2, s[32:35], s81 offen lds
    s_add_u32 m0, s75, 3072
    s_add_u32 s81, s76, 30720
    buffer_load_dwordx4 v3, s[32:35], s81 offen lds
    s_add_u32 m0, s75, 16384
    s_add_u32 s81, s76, 163840
    buffer_load_dwordx4 v2, s[32:35], s81 offen lds
    s_add_u32 m0, s75, 17408
    s_add_u32 s81, s76, 174080
    buffer_load_dwordx4 v3, s[32:35], s81 offen lds
    s_add_u32 m0, s75, 18432
    s_add_u32 s81, s76, 184320
    buffer_load_dwordx4 v2, s[32:35], s81 offen lds
    s_add_u32 m0, s75, 19456
    s_add_u32 s81, s76, 194560
    buffer_load_dwordx4 v3, s[32:35], s81 offen lds
    s_add_u32 s75, s75, 32768
    s_sub_u32 s79, s75, 98304
    s_cmp_ge_u32 s75, s77
    s_cselect_b32 s75, s79, s75
    s_add_u32 s76, s76, 128
    s_lshl_b32 s67, s60, 6
    v_add_u32 v17, s67, v0
    s_cmp_ge_u32 s26, 18
    s_cbranch_scc1 K1_LD_QKV
    s_add_u32 s70, s60, 4
    s_sub_u32 s62, s60, 2
    s_cmp_ge_u32 s60, 2
    s_cselect_b32 s70, s62, s70
    s_add_u32 s62, s60, 2
    s_lshl_b32 s67, s60, 6
    v_add_u32 v11, s67, v0
    v_mul_u32_u24 v12, 5462, v11
    v_lshrrev_b32 v12, 16, v12
    v_mul_u32_u24 v13, 12, v12
    v_sub_u32 v13, v11, v13
    v_bfe_u32 v14, v12, 3, 1
    v_lshlrev_b32 v14, 1, v14
    v_xor_b32 v13, v13, v14
    v_mul_u32_u24 v12, 3456, v12
    v_lshl_add_u32 v8, v13, 4, v12
    s_lshl_b32 s67, s70, 6
    v_add_u32 v11, s67, v0
    v_mul_u32_u24 v12, 5462, v11
    v_lshrrev_b32 v12, 16, v12
    v_mul_u32_u24 v13, 12, v12
    v_sub_u32 v13, v11, v13
    v_bfe_u32 v14, v12, 3, 1
    v_lshlrev_b32 v14, 1, v14
    v_xor_b32 v13, v13, v14
    v_mul_u32_u24 v12, 3456, v12
    v_lshl_add_u32 v9, v13, 4, v12
    s_lshl_b32 s67, s62, 6
    v_add_u32 v11, s67, v0
    v_mul_u32_u24 v12, 5462, v11
    v_lshrrev_b32 v12, 16, v12
    v_mul_u32_u24 v13, 12, v12
    v_sub_u32 v13, v11, v13
    v_bfe_u32 v14, v12, 3, 1
    v_lshlrev_b32 v14, 1, v14
    v_xor_b32 v13, v13, v14
    v_mul_u32_u24 v12, 3456, v12
    v_lshl_add_u32 v10, v13, 4, v12
    s_mov_b32 s68, 110592
    s_mul_i32 s69, s26, 192
    v_lshrrev_b32 v11, 5, v17
    v_and_b32 v12, 15, v17
    v_lshl_add_u32 v11, v11, 4, v12
    v_bfe_u32 v12, v17, 4, 1
    v_mul_u32_u24 v12, 1728, v12
    s_mul_i32 s67, s26, 96
    s_add_u32 s67, s67, 1920
    v_add3_u32 v16, v11, v12, s67
    s_branch K1_LD_GO
K1_LD_QKV:
    s_cmp_ge_u32 s26, 22
    s_cselect_b32 s70, 1120, 0
    s_lshl_b32 s67, s60, 6
    s_add_u32 s67, s67, 0
    v_add_u32 v11, s67, v0
    v_mul_u32_u24 v12, 3277, v11
    v_lshrrev_b32 v12, 16, v12
    v_mul_u32_u24 v13, 20, v12
    v_sub_u32 v13, v11, v13
    v_bfe_u32 v14, v12, 3, 1
    v_lshlrev_b32 v14, 1, v14
    v_xor_b32 v13, v13, v14
    v_mul_u32_u24 v12, 3840, v12
    v_lshl_add_u32 v8, v13, 4, v12
    v_mov_b32 v14, s70
    v_cmp_le_u32 vcc, 10, v13
    s_nop 1
    v_cndmask_b32 v14, 0, v14, vcc
    v_add_u32 v8, v8, v14
    s_lshl_b32 s67, s60, 6
    s_add_u32 s67, s67, 256
    v_add_u32 v11, s67, v0
    v_mul_u32_u24 v12, 3277, v11
    v_lshrrev_b32 v12, 16, v12
    v_mul_u32_u24 v13, 20, v12
    v_sub_u32 v13, v11, v13
    v_bfe_u32 v14, v12, 3, 1
    v_lshlrev_b32 v14, 1, v14
    v_xor_b32 v13, v13, v14
    v_mul_u32_u24 v12, 3840, v12
    v_lshl_add_u32 v9, v13, 4, v12
    v_mov_b32 v14, s70
    v_cmp_le_u32 vcc, 10, v13
    s_nop 1
    v_cndmask_b32 v14, 0, v14, vcc
    v_add_u32 v9, v9, v14
    s_lshl_b32 s67, s60, 6
    s_add_u32 s67, s67, 512
    v_add_u32 v11, s67, v0
    v_subrev_u32 v14, 128, v11
    v_cmp_le_u32 vcc, 640, v11
    s_nop 1
    v_cndmask_b32 v11, v11, v14, vcc
    v_mul_u32_u24 v12, 3277, v11
    v_lshrrev_b32 v12, 16, v12
    v_mul_u32_u24 v13, 20, v12
    v_sub_u32 v13, v11, v13
    v_bfe_u32 v14, v12, 3, 1
    v_lshlrev_b32 v14, 1, v14
    v_xor_b32 v13, v13, v14
    v_mul_u32_u24 v12, 3840, v12
    v_lshl_add_u32 v10, v13, 4, v12
    v_mov_b32 v14, s70
    v_cmp_le_u32 vcc, 10, v13
    s_nop 1
    v_cndmask_b32 v14, 0, v14, vcc
    v_add_u32 v10, v10, v14
    s_mov_b32 s68, 122880
    s_sub_u32 s69, s26, 18
    s_mul_i32 s69, s69, 320
    s_sub_u32 s71, s26, 22
    s_mul_i32 s71, s71, 160
    s_add_u32 s71, s71, 1280
    s_cmp_ge_u32 s26, 22
    s_cselect_b32 s69, s71, s69
    s_lshr_b32 s67, s69, 1
    s_lshr_b32 s71, s70, 1
    v_mov_b32 v14, s71
    v_cmp_le_u32 vcc, 80, v17
    s_nop 1
    v_cndmask_b32 v14, 0, v14, vcc
    v_add3_u32 v16, v17, v14, s67
K1_LD_GO:
    s_lshl_b32 s64, s60, 10
    s_add_u32 s65, s64, 4096
    s_add_u32 s66, s64, 8192
    s_mul_i32 s38, s68, 20
    s_mov_b32 s39, 0x20000
    s_mov_b32 s42, s38
    s_mov_b32 s43, 0x20000
    s_mov_b32 s46, s38
    s_mov_b32 s47, 0x20000
    s_cmp_ge_u32 s60, 2
    s_cselect_b64 s[40:41], s[14:15], s[12:13]
    s_cmp_ge_u32 s26, 18
    s_cselect_b64 s[36:37], s[6:7], s[12:13]
    s_cselect_b64 s[40:41], s[6:7], s[40:41]
    s_cselect_b64 s[44:45], s[6:7], s[14:15]
    s_and_b32 s37, s37, 0xffff
    s_and_b32 s41, s41, 0xffff
    s_and_b32 s45, s45, 0xffff
    s_add_u32 m0, s74, s64
    s_nop 0
    buffer_load_dwordx4 v8, s[36:39], s69 offen lds
    s_add_u32 m0, s74, s65
    s_nop 0
    buffer_load_dwordx4 v9, s[40:43], s69 offen lds
    s_add_u32 m0, s74, s66
    s_nop 0
    buffer_load_dwordx4 v10, s[44:47], s69 offen lds
    s_add_u32 s74, s74, 12288
    s_cmp_ge_u32 s74, 159744
    s_cselect_b32 s74, 98304, s74
    s_add_u32 s69, s69, s68
    s_add_u32 m0, s74, s64
    s_nop 0
    buffer_load_dwordx4 v8, s[36:39], s69 offen lds
    s_add_u32 m0, s74, s65
    s_nop 0
    buffer_load_dwordx4 v9, s[40:43], s69 offen lds
    s_add_u32 m0, s74, s66
    s_nop 0
    buffer_load_dwordx4 v10, s[44:47], s69 offen lds
    s_add_u32 s74, s74, 12288
    s_cmp_ge_u32 s74, 159744
    s_cselect_b32 s74, 98304, s74
    s_add_u32 s69, s69, s68
    s_mov_b32 s61, 2
    s_mov_b32 s62, s27
    s_cmp_eq_u32 s60, 3
    s_cbranch_scc1 K1_ST_DEC
    s_mul_i32 s63, s53, 3
    s_add_u32 s63, s63, s60
    s_mov_b32 s61, 1
    s_lshl_b32 s67, s54, 3
    s_lshr_b32 s70, 0x150f0800, s67
    s_and_b32 s70, s70, 255
    s_lshr_b32 s71, 0x06060708, s67
    s_and_b32 s71, s71, 255
    s_lshr_b32 s72, 0x170f0800, s67
    s_and_b32 s72, s72, 255
    s_lshr_b32 s73, 0x07080708, s67
    s_and_b32 s73, s73, 255
    s_add_u32 s62, s70, s63
    s_add_u32 s62, s62, 30
    s_sub_u32 s67, s62, s71
    s_add_u32 s67, s67, 27
    s_cmp_ge_u32 s63, s71
    s_cselect_b32 s62, s67, s62
    s_lshl_b32 s71, s71, 1
    s_sub_u32 s67, s63, s71
    s_add_u32 s72, s72, s67
    s_cmp_ge_u32 s63, s71
    s_cselect_b32 s62, s72, s62
    s_add_u32 s71, s71, s73
    s_cmp_ge_u32 s63, s71
    s_cselect_b32 s61, 0, s61
    s_cselect_b32 s67, 1, 0
    s_cmp_eq_u32 s54, 3
    s_cselect_b32 s67, s67, 0
    s_cmp_eq_u32 s67, 1
    s_cselect_b32 s61, 2, s61
K1_ST_DEC:
    s_movk_i32 s63, 3840
    s_cmp_ge_u32 s62, 30
    s_cselect_b32 s63, 3456, s63
    s_cselect_b32 s67, 30, 0
    s_cmp_ge_u32 s62, 57
    s_cselect_b32 s67, 57, s67
    s_sub_u32 s70, s62, s67
    s_lshl_b32 s70, s70, 7
    s_lshl_b32 s71, s25, 3
    s_mul_i32 s71, s71, s63
    s_add_u32 s70, s70, s71
    s_lshl_b32 s71, s63, 6
    s_mul_i32 s78, s63, 640
    s_lshl_b32 s72, s25, 8
    s_lshl_b32 s73, s62, 3
    s_add_u32 s72, s72, s73
    s_mul_i32 s73, s72, 1280
    s_cmp_eq_u32 s61, 2
    s_cselect_b32 s63, 1280, s63
    s_cselect_b32 s70, s73, s70
    s_cselect_b32 s71, 128, s71
    s_cselect_b32 s78, 2621440, s78
    s_cmp_eq_u32 s61, 0
    s_cselect_b32 s78, 0, s78
    v_mov_b32 v19, 0
    v_mul_lo_u32 v18, v4, s63
    v_lshl_add_u32 v18, v6, 4, v18
    s_cmp_ge_u32 s62, 30
    s_cselect_b64 s[8:9], s[12:13], s[6:7]
    s_cmp_ge_u32 s62, 57
    s_cselect_b64 s[8:9], s[14:15], s[8:9]
    s_cmp_eq_u32 s61, 2
    s_cselect_b64 s[8:9], s[4:5], s[8:9]
    s_and_b32 s9, s9, 0xffff
    s_mov_b32 s10, s78
    s_mov_b32 s11, 0x20000
    s_mov_b32 s56, s20
    s_and_b32 s57, s21, 0xffff
    s_mov_b32 s58, 256
    s_mov_b32 s59, 0x20000
    s_mul_i32 s73, s71, 1
    s_add_u32 s73, s73, s70
    buffer_load_dwordx4 v[32:35], v18, s[8:11], s73 offen
    s_mul_i32 s73, s71, 2
    s_add_u32 s73, s73, s70
    buffer_load_dwordx4 v[36:39], v18, s[8:11], s73 offen
    s_mul_i32 s73, s71, 3
    s_add_u32 s73, s73, s70
    buffer_load_dwordx4 v[40:43], v18, s[8:11], s73 offen
    s_mul_i32 s73, s71, 4
    s_add_u32 s73, s73, s70
    buffer_load_dwordx4 v[44:47], v18, s[8:11], s73 offen
    s_mul_i32 s73, s71, 5
    s_add_u32 s73, s73, s70
    buffer_load_dwordx4 v[48:51], v18, s[8:11], s73 offen
    s_mul_i32 s73, s71, 6
    s_add_u32 s73, s73, s70
    buffer_load_dwordx4 v[52:55], v18, s[8:11], s73 offen
    s_mul_i32 s73, s71, 7
    s_add_u32 s73, s73, s70
    buffer_load_dwordx4 v[56:59], v18, s[8:11], s73 offen
    s_mul_i32 s73, s71, 8
    s_add_u32 s73, s73, s70
    buffer_load_dwordx4 v[60:63], v18, s[8:11], s73 offen
    s_mul_i32 s73, s71, 9
    s_add_u32 s73, s73, s70
    buffer_load_dwordx4 v[64:67], v18, s[8:11], s73 offen
    s_mul_i32 s73, s71, 0
    s_add_u32 s73, s73, s70
    buffer_load_dwordx4 v[68:71], v18, s[8:11], s73 offen
    s_waitcnt vmcnt(13)
    s_barrier
    s_waitcnt vmcnt(10)
    s_barrier
    s_add_u32 m0, s75, 0
    s_add_u32 s81, s76, 0
    buffer_load_dwordx4 v2, s[32:35], s81 offen lds
    s_add_u32 m0, s75, 1024
    s_add_u32 s81, s76, 10240
    buffer_load_dwordx4 v3, s[32:35], s81 offen lds
    s_add_u32 m0, s75, 2048
    s_add_u32 s81, s76, 20480
    buffer_load_dwordx4 v2, s[32:35], s81 offen lds
    s_add_u32 m0, s75, 3072
    s_add_u32 s81, s76, 30720
    buffer_load_dwordx4 v3, s[32:35], s81 offen lds
    s_add_u32 m0, s74, s64
    s_nop 0
    buffer_load_dwordx4 v8, s[36:39], s69 offen lds
    s_add_u32 m0, s74, s65
    s_nop 0
    buffer_load_dwordx4 v9, s[40:43], s69 offen lds
    s_add_u32 m0, s74, s66
    s_nop 0
    buffer_load_dwordx4 v10, s[44:47], s69 offen lds
    s_add_u32 s74, s74, 12288
    s_cmp_ge_u32 s74, 159744
    s_cselect_b32 s74, 98304, s74
    s_add_u32 s69, s69, s68
    s_add_u32 m0, s75, 16384
    s_add_u32 s81, s76, 163840
    buffer_load_dwordx4 v2, s[32:35], s81 offen lds
    s_add_u32 m0, s75, 17408
    s_add_u32 s81, s76, 174080
    buffer_load_dwordx4 v3, s[32:35], s81 offen lds
    s_add_u32 m0, s75, 18432
    s_add_u32 s81, s76, 184320
    buffer_load_dwordx4 v2, s[32:35], s81 offen lds
    s_add_u32 m0, s75, 19456
    s_add_u32 s81, s76, 194560
    buffer_load_dwordx4 v3, s[32:35], s81 offen lds
    s_add_u32 s75, s75, 32768
    s_sub_u32 s79, s75, 98304
    s_cmp_ge_u32 s75, s77
    s_cselect_b32 s75, s79, s75
    s_add_u32 s76, s76, 128
    s_add_u32 m0, s74, s64
    s_nop 0
    buffer_load_dwordx4 v8, s[36:39], s69 offen lds
    s_add_u32 m0, s74, s65
    s_nop 0
    buffer_load_dwordx4 v9, s[40:43], s69 offen lds
    s_add_u32 m0, s74, s66
    s_nop 0
    buffer_load_dwordx4 v10, s[44:47], s69 offen lds
    s_add_u32 s74, s74, 12288
    s_cmp_ge_u32 s74, 159744
    s_cselect_b32 s74, 98304, s74
    s_add_u32 s69, s69, s68
    s_add_u32 m0, s75, 0
    s_add_u32 s81, s76, 0
    buffer_load_dwordx4 v2, s[32:35], s81 offen lds
    s_add_u32 m0, s75, 1024
    s_add_u32 s81, s76, 10240
    buffer_load_dwordx4 v3, s[32:35], s81 offen lds
    s_add_u32 m0, s75, 2048
    s_add_u32 s81, s76, 20480
    buffer_load_dwordx4 v2, s[32:35], s81 offen lds
    s_add_u32 m0, s75, 3072
    s_add_u32 s81, s76, 30720
    buffer_load_dwordx4 v3, s[32:35], s81 offen lds
    s_waitcnt vmcnt(7)
    s_barrier
    s_add_u32 m0, s74, s64
    s_nop 0
    buffer_load_dwordx4 v8, s[36:39], s69 offen lds
    s_add_u32 m0, s74, s65
    s_nop 0
    buffer_load_dwordx4 v9, s[40:43], s69 offen lds
    s_add_u32 m0, s74, s66
    s_nop 0
    buffer_load_dwordx4 v10, s[44:47], s69 offen lds
    s_add_u32 s74, s74, 12288
    s_cmp_ge_u32 s74, 159744
    s_cselect_b32 s74, 98304, s74
    s_add_u32 s69, s69, s68
    s_add_u32 m0, s75, 16384
    s_add_u32 s81, s76, 163840
    buffer_load_dwordx4 v2, s[32:35], s81 offen lds
    s_add_u32 m0, s75, 17408
    s_add_u32 s81, s76, 174080
    buffer_load_dwordx4 v3, s[32:35], s81 offen lds
    s_add_u32 m0, s75, 18432
    s_add_u32 s81, s76, 184320
    buffer_load_dwordx4 v2, s[32:35], s81 offen lds
    s_add_u32 m0, s75, 19456
    s_add_u32 s81, s76, 194560
    buffer_load_dwordx4 v3, s[32:35], s81 offen lds
    s_add_u32 s75, s75, 32768
    s_sub_u32 s79, s75, 98304
    s_cmp_ge_u32 s75, s77
    s_cselect_b32 s75, s79, s75
    s_add_u32 s76, s76, 128
    s_add_u32 m0, s74, s64
    s_nop 0
    buffer_load_dwordx4 v8, s[36:39], s69 offen lds
    s_add_u32 m0, s74, s65
    s_nop 0
    buffer_load_dwordx4 v9, s[40:43], s69 offen lds
    s_add_u32 m0, s74, s66
    s_nop 0
    buffer_load_dwordx4 v10, s[44:47], s69 offen lds
    s_add_u32 s74, s74, 12288
    s_cmp_ge_u32 s74, 159744
    s_cselect_b32 s74, 98304, s74
    s_add_u32 s69, s69, s68
    s_add_u32 m0, s75, 0
    s_add_u32 s81, s76, 0
    buffer_load_dwordx4 v2, s[32:35], s81 offen lds
    s_add_u32 m0, s75, 1024
    s_add_u32 s81, s76, 10240
    buffer_load_dwordx4 v3, s[32:35], s81 offen lds
    s_add_u32 m0, s75, 2048
    s_add_u32 s81, s76, 20480
    buffer_load_dwordx4 v2, s[32:35], s81 offen lds
    s_add_u32 m0, s75, 3072
    s_add_u32 s81, s76, 30720
    buffer_load_dwordx4 v3, s[32:35], s81 offen lds
    buffer_load_dword v13, off, s[56:59], 0 sc1
    v_lshlrev_b32 v72, 16, v32
    v_and_b32 v73, 0xffff0000, v32
    v_lshlrev_b32 v74, 16, v33
    v_and_b32 v75, 0xffff0000, v33
    v_lshlrev_b32 v76, 16, v34
    v_and_b32 v77, 0xffff0000, v34
    v_lshlrev_b32 v78, 16, v35
    v_and_b32 v79, 0xffff0000, v35
    v_lshlrev_b32 v80, 16, v36
    v_and_b32 v81, 0xffff0000, v36
    v_lshlrev_b32 v82, 16, v37
    v_and_b32 v83, 0xffff0000, v37
    v_lshlrev_b32 v84, 16, v38
    v_and_b32 v85, 0xffff0000, v38
    v_lshlrev_b32 v86, 16, v39
    v_and_b32 v87, 0xffff0000, v39
    v_pk_add_f32 v[20:21], v[72:73], v[80:81]
    v_pk_add_f32 v[22:23], v[74:75], v[82:83]
    v_pk_add_f32 v[24:25], v[76:77], v[84:85]
    v_pk_add_f32 v[26:27], v[78:79], v[86:87]
    v_lshlrev_b32 v88, 16, v40
    v_and_b32 v89, 0xffff0000, v40
    v_lshlrev_b32 v90, 16, v41
    v_and_b32 v91, 0xffff0000, v41
    v_lshlrev_b32 v92, 16, v42
    v_and_b32 v93, 0xffff0000, v42
    v_lshlrev_b32 v94, 16, v43
    v_and_b32 v95, 0xffff0000, v43
    v_pk_add_f32 v[20:21], v[20:21], v[88:89]
    v_pk_add_f32 v[22:23], v[22:23], v[90:91]
    v_pk_add_f32 v[24:25], v[24:25], v[92:93]
    v_pk_add_f32 v[26:27], v[26:27], v[94:95]
    v_lshlrev_b32 v96, 16, v44
    v_and_b32 v97, 0xffff0000, v44
    v_lshlrev_b32 v98, 16, v45
    v_and_b32 v99, 0xffff0000, v45
    v_lshlrev_b32 v100, 16, v46
    v_and_b32 v101, 0xffff0000, v46
    v_lshlrev_b32 v102, 16, v47
    v_and_b32 v103, 0xffff0000, v47
    v_pk_add_f32 v[20:21], v[20:21], v[96:97]
    v_pk_add_f32 v[22:23], v[22:23], v[98:99]
    v_pk_add_f32 v[24:25], v[24:25], v[100:101]
    v_pk_add_f32 v[26:27], v[26:27], v[102:103]
    v_lshlrev_b32 v104, 16, v48
    v_and_b32 v105, 0xffff0000, v48
    v_lshlrev_b32 v106, 16, v49
    v_and_b32 v107, 0xffff0000, v49
    v_lshlrev_b32 v108, 16, v50
    v_and_b32 v109, 0xffff0000, v50
    v_lshlrev_b32 v110, 16, v51
    v_and_b32 v111, 0xffff0000, v51
    v_pk_add_f32 v[20:21], v[20:21], v[104:105]
    v_pk_add_f32 v[22:23], v[22:23], v[106:107]
    v_pk_add_f32 v[24:25], v[24:25], v[108:109]
    v_pk_add_f32 v[26:27], v[26:27], v[110:111]
    s_waitcnt vmcnt(19)
    s_barrier
    s_add_u32 m0, s74, s64
    s_nop 0
    buffer_load_dwordx4 v8, s[36:39], s69 offen lds
    s_add_u32 m0, s74, s65
    s_nop 0
    buffer_load_dwordx4 v9, s[40:43], s69 offen lds
    s_add_u32 m0, s74, s66
    s_nop 0
    buffer_load_dwordx4 v10, s[44:47], s69 offen lds
    s_add_u32 s74, s74, 12288
    s_cmp_ge_u32 s74, 159744
    s_cselect_b32 s74, 98304, s74
    s_add_u32 s69, s69, s68
    s_add_u32 m0, s75, 16384
    s_add_u32 s81, s76, 163840
    buffer_load_dwordx4 v2, s[32:35], s81 offen lds
    s_add_u32 m0, s75, 17408
    s_add_u32 s81, s76, 174080
    buffer_load_dwordx4 v3, s[32:35], s81 offen lds
    s_add_u32 m0, s75, 18432
    s_add_u32 s81, s76, 184320
    buffer_load_dwordx4 v2, s[32:35], s81 offen lds
    s_add_u32 m0, s75, 19456
    s_add_u32 s81, s76, 194560
    buffer_load_dwordx4 v3, s[32:35], s81 offen lds
    s_add_u32 s75, s75, 32768
    s_sub_u32 s79, s75, 98304
    s_cmp_ge_u32 s75, s77
    s_cselect_b32 s75, s79, s75
    s_add_u32 s76, s76, 128
    s_add_u32 m0, s74, s64
    s_nop 0
    buffer_load_dwordx4 v8, s[36:39], s69 offen lds
    s_add_u32 m0, s74, s65
    s_nop 0
    buffer_load_dwordx4 v9, s[40:43], s69 offen lds
    s_add_u32 m0, s74, s66
    s_nop 0
    buffer_load_dwordx4 v10, s[44:47], s69 offen lds
    s_add_u32 s74, s74, 12288
    s_cmp_ge_u32 s74, 159744
    s_cselect_b32 s74, 98304, s74
    s_add_u32 s69, s69, s68
    v_lshlrev_b32 v112, 16, v52
    v_and_b32 v113, 0xffff0000, v52
    v_lshlrev_b32 v114, 16, v53
    v_and_b32 v115, 0xffff0000, v53
    v_lshlrev_b32 v116, 16, v54
    v_and_b32 v117, 0xffff0000, v54
    v_lshlrev_b32 v118, 16, v55
    v_and_b32 v119, 0xffff0000, v55
    v_pk_add_f32 v[20:21], v[20:21], v[112:113]
    v_pk_add_f32 v[22:23], v[22:23], v[114:115]
    v_pk_add_f32 v[24:25], v[24:25], v[116:117]
    v_pk_add_f32 v[26:27], v[26:27], v[118:119]
    v_lshlrev_b32 v120, 16, v56
    v_and_b32 v121, 0xffff0000, v56
    v_lshlrev_b32 v122, 16, v57
    v_and_b32 v123, 0xffff0000, v57
    v_lshlrev_b32 v124, 16, v58
    v_and_b32 v125, 0xffff0000, v58
    v_lshlrev_b32 v126, 16, v59
    v_and_b32 v127, 0xffff0000, v59
    v_pk_add_f32 v[20:21], v[20:21], v[120:121]
    v_pk_add_f32 v[22:23], v[22:23], v[122:123]
    v_pk_add_f32 v[24:25], v[24:25], v[124:125]
    v_pk_add_f32 v[26:27], v[26:27], v[126:127]
    v_lshlrev_b32 v128, 16, v60
    v_and_b32 v129, 0xffff0000, v60
    v_lshlrev_b32 v130, 16, v61
    v_and_b32 v131, 0xffff0000, v61
    v_lshlrev_b32 v132, 16, v62
    v_and_b32 v133, 0xffff0000, v62
    v_lshlrev_b32 v134, 16, v63
    v_and_b32 v135, 0xffff0000, v63
    v_pk_add_f32 v[20:21], v[20:21], v[128:129]
    v_pk_add_f32 v[22:23], v[22:23], v[130:131]
    v_pk_add_f32 v[24:25], v[24:25], v[132:133]
    v_pk_add_f32 v[26:27], v[26:27], v[134:135]
    v_lshlrev_b32 v136, 16, v64
    v_and_b32 v137, 0xffff0000, v64
    v_lshlrev_b32 v138, 16, v65
    v_and_b32 v139, 0xffff0000, v65
    v_lshlrev_b32 v140, 16, v66
    v_and_b32 v141, 0xffff0000, v66
    v_lshlrev_b32 v142, 16, v67
    v_and_b32 v143, 0xffff0000, v67
    v_pk_add_f32 v[20:21], v[20:21], v[136:137]
    v_pk_add_f32 v[22:23], v[22:23], v[138:139]
    v_pk_add_f32 v[24:25], v[24:25], v[140:141]
    v_pk_add_f32 v[26:27], v[26:27], v[142:143]
    v_lshlrev_b32 v144, 16, v68
    v_and_b32 v145, 0xffff0000, v68
    v_lshlrev_b32 v146, 16, v69
    v_and_b32 v147, 0xffff0000, v69
    v_lshlrev_b32 v148, 16, v70
    v_and_b32 v149, 0xffff0000, v70
    v_lshlrev_b32 v150, 16, v71
    v_and_b32 v151, 0xffff0000, v71
    v_pk_add_f32 v[20:21], v[20:21], v[144:145]
    v_pk_add_f32 v[22:23], v[22:23], v[146:147]
    v_pk_add_f32 v[24:25], v[24:25], v[148:149]
    v_pk_add_f32 v[26:27], v[26:27], v[150:151]
    s_waitcnt vmcnt(18)
    s_barrier
    s_add_u32 m0, s75, 0
    s_add_u32 s81, s76, 0
    buffer_load_dwordx4 v2, s[32:35], s81 offen lds
    s_add_u32 m0, s75, 1024
    s_add_u32 s81, s76, 10240
    buffer_load_dwordx4 v3, s[32:35], s81 offen lds
    s_add_u32 m0, s75, 2048
    s_add_u32 s81, s76, 20480
    buffer_load_dwordx4 v2, s[32:35], s81 offen lds
    s_add_u32 m0, s75, 3072
    s_add_u32 s81, s76, 30720
    buffer_load_dwordx4 v3, s[32:35], s81 offen lds
    s_add_u32 m0, s74, s64
    s_nop 0
    buffer_load_dwordx4 v8, s[36:39], s69 offen lds
    s_add_u32 m0, s74, s65
    s_nop 0
    buffer_load_dwordx4 v9, s[40:43], s69 offen lds
    s_add_u32 m0, s74, s66
    s_nop 0
    buffer_load_dwordx4 v10, s[44:47], s69 offen lds
    s_add_u32 s74, s74, 12288
    s_cmp_ge_u32 s74, 159744
    s_cselect_b32 s74, 98304, s74
    s_add_u32 s69, s69, s68
    s_add_u32 m0, s75, 16384
    s_add_u32 s81, s76, 163840
    buffer_load_dwordx4 v2, s[32:35], s81 offen lds
    s_add_u32 m0, s75, 17408
    s_add_u32 s81, s76, 174080
    buffer_load_dwordx4 v3, s[32:35], s81 offen lds
    s_add_u32 m0, s75, 18432
    s_add_u32 s81, s76, 184320
    buffer_load_dwordx4 v2, s[32:35], s81 offen lds
    s_add_u32 m0, s75, 19456
    s_add_u32 s81, s76, 194560
    buffer_load_dwordx4 v3, s[32:35], s81 offen lds
    s_add_u32 s75, s75, 32768
    s_sub_u32 s79, s75, 98304
    s_cmp_ge_u32 s75, s77
    s_cselect_b32 s75, s79, s75
    s_add_u32 s76, s76, 128
    s_cmp_eq_u32 s61, 2
    s_cbranch_scc1 K1_STR_1
    v_lshl_add_u32 v19, v6, 3, v4
    v_lshlrev_b32 v19, 3, v19
    s_lshl_b32 s70, s62, 9
    s_mul_i32 s71, s25, 43008
    s_add_u32 s70, s70, s71
    s_add_u32 s70, s70, 13860864
    s_cmp_eq_u32 s61, 0
    s_cselect_b32 s70, 1073741824, s70
    v_and_b32 v7, 8, v0
    v_cmp_eq_u32 s[82:83], 0, v7
    v_permlane32_swap_b32 v20, v24
    v_permlane32_swap_b32 v21, v25
    v_permlane32_swap_b32 v22, v26
    v_permlane32_swap_b32 v23, v27
    v_add_f32 v20, v20, v24
    v_add_f32 v21, v21, v25
    v_add_f32 v22, v22, v26
    v_add_f32 v23, v23, v27
    s_nop 0
    v_permlane16_swap_b32 v20, v22
    v_permlane16_swap_b32 v21, v23
    v_add_f32 v20, v20, v22
    v_add_f32 v21, v21, v23
    v_cndmask_b32 v22, v21, v20, s[82:83]
    v_cndmask_b32 v23, v20, v21, s[82:83]
    s_nop 1
    v_add_f32_dpp v20, v23, v22 row_ror:8 row_mask:0xf bank_mask:0xf
    s_branch K1_STE_2
K1_STR_1:
    s_nop 1
    v_pk_add_f32 v[20:21], v[20:21], v[22:23]
    v_pk_add_f32 v[24:25], v[24:25], v[26:27]
    v_pk_add_f32 v[20:21], v[20:21], v[24:25]
    v_add_f32 v20, v20, v21
    s_nop 1
    v_add_f32_dpp v20, v20, v20 quad_perm:[1,0,3,2] row_mask:0xf bank_mask:0xf
    s_nop 1
    v_add_f32_dpp v20, v20, v20 quad_perm:[2,3,0,1] row_mask:0xf bank_mask:0xf
    s_nop 1
    v_add_f32_dpp v20, v20, v20 row_half_mirror row_mask:0xf bank_mask:0xf
    v_mul_f32 v20, 0xbacccccd, v20
    v_pk_add_f32 v[72:73], v[72:73], v[20:21] op_sel_hi:[1,0]
    v_pk_mul_f32 v[22:23], v[72:73], v[72:73]
    v_pk_add_f32 v[74:75], v[74:75], v[20:21] op_sel_hi:[1,0]
    v_pk_mul_f32 v[24:25], v[74:75], v[74:75]
    v_pk_add_f32 v[76:77], v[76:77], v[20:21] op_sel_hi:[1,0]
    v_pk_fma_f32 v[22:23], v[76:77], v[76:77], v[22:23]
    v_pk_add_f32 v[78:79], v[78:79], v[20:21] op_sel_hi:[1,0]
    v_pk_fma_f32 v[24:25], v[78:79], v[78:79], v[24:25]
    v_pk_add_f32 v[80:81], v[80:81], v[20:21] op_sel_hi:[1,0]
    v_pk_fma_f32 v[22:23], v[80:81], v[80:81], v[22:23]
    v_pk_add_f32 v[82:83], v[82:83], v[20:21] op_sel_hi:[1,0]
    v_pk_fma_f32 v[24:25], v[82:83], v[82:83], v[24:25]
    v_pk_add_f32 v[84:85], v[84:85], v[20:21] op_sel_hi:[1,0]
    v_pk_fma_f32 v[22:23], v[84:85], v[84:85], v[22:23]
    v_pk_add_f32 v[86:87], v[86:87], v[20:21] op_sel_hi:[1,0]
    v_pk_fma_f32 v[24:25], v[86:87], v[86:87], v[24:25]
    v_pk_add_f32 v[88:89], v[88:89], v[20:21] op_sel_hi:[1,0]
    v_pk_fma_f32 v[22:23], v[88:89], v[88:89], v[22:23]
    v_pk_add_f32 v[90:91], v[90:91], v[20:21] op_sel_hi:[1,0]
    v_pk_fma_f32 v[24:25], v[90:91], v[90:91], v[24:25]
    v_pk_add_f32 v[92:93], v[92:93], v[20:21] op_sel_hi:[1,0]
    v_pk_fma_f32 v[22:23], v[92:93], v[92:93], v[22:23]
    v_pk_add_f32 v[94:95], v[94:95], v[20:21] op_sel_hi:[1,0]
    v_pk_fma_f32 v[24:25], v[94:95], v[94:95], v[24:25]
    v_pk_add_f32 v[96:97], v[96:97], v[20:21] op_sel_hi:[1,0]
    v_pk_fma_f32 v[22:23], v[96:97], v[96:97], v[22:23]
    v_pk_add_f32 v[98:99], v[98:99], v[20:21] op_sel_hi:[1,0]
    v_pk_fma_f32 v[24:25], v[98:99], v[98:99], v[24:25]
    v_pk_add_f32 v[100:101], v[100:101], v[20:21] op_sel_hi:[1,0]
    v_pk_fma_f32 v[22:23], v[100:101], v[100:101], v[22:23]
    v_pk_add_f32 v[102:103], v[102:103], v[20:21] op_sel_hi:[1,0]
    v_pk_fma_f32 v[24:25], v[102:103], v[102:103], v[24:25]
    v_pk_add_f32 v[104:105], v[104:105], v[20:21] op_sel_hi:[1,0]
    v_pk_fma_f32 v[22:23], v[104:105], v[104:105], v[22:23]
    v_pk_add_f32 v[106:107], v[106:107], v[20:21] op_sel_hi:[1,0]
    v_pk_fma_f32 v[24:25], v[106:107], v[106:107], v[24:25]
    v_pk_add_f32 v[108:109], v[108:109], v[20:21] op_sel_hi:[1,0]
    v_pk_fma_f32 v[22:23], v[108:109], v[108:109], v[22:23]
    v_pk_add_f32 v[110:111], v[110:111], v[20:21] op_sel_hi:[1,0]
    v_pk_fma_f32 v[24:25], v[110:111], v[110:111], v[24:25]
    v_pk_add_f32 v[112:113], v[112:113], v[20:21] op_sel_hi:[1,0]
    v_pk_fma_f32 v[22:23], v[112:113], v[112:113], v[22:23]
    v_pk_add_f32 v[114:115], v[114:115], v[20:21] op_sel_hi:[1,0]
    v_pk_fma_f32 v[24:25], v[114:115], v[114:115], v[24:25]
    v_pk_add_f32 v[116:117], v[116:117], v[20:21] op_sel_hi:[1,0]
    v_pk_fma_f32 v[22:23], v[116:117], v[116:117], v[22:23]
    v_pk_add_f32 v[118:119], v[118:119], v[20:21] op_sel_hi:[1,0]
    v_pk_fma_f32 v[24:25], v[118:119], v[118:119], v[24:25]
    v_pk_add_f32 v[120:121], v[120:121], v[20:21] op_sel_hi:[1,0]
    v_pk_fma_f32 v[22:23], v[120:121], v[120:121], v[22:23]
    v_pk_add_f32 v[122:123], v[122:123], v[20:21] op_sel_hi:[1,0]
    v_pk_fma_f32 v[24:25], v[122:123], v[122:123], v[24:25]
K1_STE_2:
    s_nop 1
    s_waitcnt vmcnt(26)
    s_barrier
    s_add_u32 m0, s74, s64
    s_nop 0
    buffer_load_dwordx4 v8, s[36:39], s69 offen lds
    s_add_u32 m0, s74, s65
    s_nop 0
    buffer_load_dwordx4 v9, s[40:43], s69 offen lds
    s_add_u32 m0, s74, s66
    s_nop 0
    buffer_load_dwordx4 v10, s[44:47], s69 offen lds
    s_add_u32 s74, s74, 12288
    s_cmp_ge_u32 s74, 159744
    s_cselect_b32 s74, 98304, s74
    s_add_u32 s69, s69, s68
    s_cmp_eq_u32 s61, 2
    s_cbranch_scc1 K1_STR_3
    s_branch K1_STE_4
K1_STR_3:
    s_nop 1
    v_pk_add_f32 v[124:125], v[124:125], v[20:21] op_sel_hi:[1,0]
    v_pk_fma_f32 v[22:23], v[124:125], v[124:125], v[22:23]
    v_pk_add_f32 v[126:127], v[126:127], v[20:21] op_sel_hi:[1,0]
    v_pk_fma_f32 v[24:25], v[126:127], v[126:127], v[24:25]
    v_pk_add_f32 v[128:129], v[128:129], v[20:21] op_sel_hi:[1,0]
    v_pk_fma_f32 v[22:23], v[128:129], v[128:129], v[22:23]
    v_pk_add_f32 v[130:131], v[130:131], v[20:21] op_sel_hi:[1,0]
    v_pk_fma_f32 v[24:25], v[130:131], v[130:131], v[24:25]
    v_pk_add_f32 v[132:133], v[132:133], v[20:21] op_sel_hi:[1,0]
    v_pk_fma_f32 v[22:23], v[132:133], v[132:133], v[22:23]
    v_pk_add_f32 v[134:135], v[134:135], v[20:21] op_sel_hi:[1,0]
    v_pk_fma_f32 v[24:25], v[134:135], v[134:135], v[24:25]
    v_pk_add_f32 v[136:137], v[136:137], v[20:21] op_sel_hi:[1,0]
    v_pk_fma_f32 v[22:23], v[136:137], v[136:137], v[22:23]
    v_pk_add_f32 v[138:139], v[138:139], v[20:21] op_sel_hi:[1,0]
    v_pk_fma_f32 v[24:25], v[138:139], v[138:139], v[24:25]
    v_pk_add_f32 v[140:141], v[140:141], v[20:21] op_sel_hi:[1,0]
    v_pk_fma_f32 v[22:23], v[140:141], v[140:141], v[22:23]
    v_pk_add_f32 v[142:143], v[142:143], v[20:21] op_sel_hi:[1,0]
    v_pk_fma_f32 v[24:25], v[142:143], v[142:143], v[24:25]
    v_pk_add_f32 v[144:145], v[144:145], v[20:21] op_sel_hi:[1,0]
    v_pk_fma_f32 v[22:23], v[144:145], v[144:145], v[22:23]
    v_pk_add_f32 v[146:147], v[146:147], v[20:21] op_sel_hi:[1,0]
    v_pk_fma_f32 v[24:25], v[146:147], v[146:147], v[24:25]
    v_pk_add_f32 v[148:149], v[148:149], v[20:21] op_sel_hi:[1,0]
    v_pk_fma_f32 v[22:23], v[148:149], v[148:149], v[22:23]
    v_pk_add_f32 v[150:151], v[150:151], v[20:21] op_sel_hi:[1,0]
    v_pk_fma_f32 v[24:25], v[150:151], v[150:151], v[24:25]
    v_pk_add_f32 v[22:23], v[22:23], v[24:25]
    v_add_f32 v22, v22, v23
    s_nop 1
    v_add_f32_dpp v22, v22, v22 quad_perm:[1,0,3,2] row_mask:0xf bank_mask:0xf
    s_nop 1
    v_add_f32_dpp v22, v22, v22 quad_perm:[2,3,0,1] row_mask:0xf bank_mask:0xf
    s_nop 1
    v_add_f32_dpp v22, v22, v22 row_half_mirror row_mask:0xf bank_mask:0xf
    v_mul_f32 v22, 0x3acccccd, v22
    v_cvt_pk_bf16_f32 v22, v22, v22
    v_and_b32 v22, 0xffff0000, v22
    v_add_f32 v22, 0x3727c5ac, v22
    v_cvt_pk_bf16_f32 v22, v22, v22
    v_and_b32 v22, 0xffff0000, v22
    v_sqrt_f32 v22, v22
    s_nop 0
    v_cvt_pk_bf16_f32 v20, v20, v22
    v_lshlrev_b32 v19, 3, v4
    v_mov_b32 v7, 1073741824
    v_cmp_eq_u32 vcc, 0, v6
    s_nop 1
    v_cndmask_b32 v19, v7, v19, vcc
    s_lshl_b32 s70, s72, 3
    s_add_u32 s70, s70, 13844480
K1_STE_4:
    s_nop 1
    s_mov_b32 s73, 0
K1_TAG_CHK:
    v_readfirstlane_b32 s78, v13
    s_nop 1
    s_cmp_lg_u32 s78, 0
    s_cbranch_scc1 K1_TAG_OK
    s_add_u32 s73, s73, 1
    s_cmp_gt_u32 s73, 200000
    s_cbranch_scc1 K1_TAG_OK
    s_sleep 8
    buffer_load_dword v13, off, s[56:59], 0 sc1
    s_waitcnt vmcnt(0)
    s_branch K1_TAG_CHK
K1_TAG_OK:
    v_mov_b32 v21, v13
    buffer_store_dwordx2 v[20:21], v19, s[48:51], s70 offen sc0 sc1
    s_waitcnt vmcnt(18)
    s_barrier
    s_add_u32 m0, s75, 0
    s_add_u32 s81, s76, 0
    buffer_load_dwordx4 v2, s[32:35], s81 offen lds
    s_add_u32 m0, s75, 1024
    s_add_u32 s81, s76, 10240
    buffer_load_dwordx4 v3, s[32:35], s81 offen lds
    s_add_u32 m0, s75, 2048
    s_add_u32 s81, s76, 20480
    buffer_load_dwordx4 v2, s[32:35], s81 offen lds
    s_add_u32 m0, s75, 3072
    s_add_u32 s81, s76, 30720
    buffer_load_dwordx4 v3, s[32:35], s81 offen lds
    s_add_u32 m0, s74, s64
    s_nop 0
    buffer_load_dwordx4 v8, s[36:39], s69 offen lds
    s_add_u32 m0, s74, s65
    s_nop 0
    buffer_load_dwordx4 v9, s[40:43], s69 offen lds
    s_add_u32 m0, s74, s66
    s_nop 0
    buffer_load_dwordx4 v10, s[44:47], s69 offen lds
    s_add_u32 s74, s74, 12288
    s_cmp_ge_u32 s74, 159744
    s_cselect_b32 s74, 98304, s74
    s_add_u32 s69, s69, s68
    s_waitcnt vmcnt(22)
    s_barrier
    s_add_u32 m0, s75, 16384
    s_add_u32 s81, s76, 163840
    buffer_load_dwordx4 v2, s[32:35], s81 offen lds
    s_add_u32 m0, s75, 17408
    s_add_u32 s81, s76, 174080
    buffer_load_dwordx4 v3, s[32:35], s81 offen lds
    s_add_u32 m0, s75, 18432
    s_add_u32 s81, s76, 184320
    buffer_load_dwordx4 v2, s[32:35], s81 offen lds
    s_add_u32 m0, s75, 19456
    s_add_u32 s81, s76, 194560
    buffer_load_dwordx4 v3, s[32:35], s81 offen lds
    s_add_u32 s75, s75, 32768
    s_sub_u32 s79, s75, 98304
    s_cmp_ge_u32 s75, s77
    s_cselect_b32 s75, s79, s75
    s_add_u32 s76, s76, 128
    s_add_u32 m0, s74, s64
    s_nop 0
    buffer_load_dwordx4 v8, s[36:39], s69 offen lds
    s_add_u32 m0, s74, s65
    s_nop 0
    buffer_load_dwordx4 v9, s[40:43], s69 offen lds
    s_add_u32 m0, s74, s66
    s_nop 0
    buffer_load_dwordx4 v10, s[44:47], s69 offen lds
    s_add_u32 s74, s74, 12288
    s_cmp_ge_u32 s74, 159744
    s_cselect_b32 s74, 98304, s74
    s_add_u32 s69, s69, s68
    s_waitcnt vmcnt(18)
    s_barrier
    s_add_u32 m0, s75, 0
    s_add_u32 s81, s76, 0
    buffer_load_dwordx4 v2, s[32:35], s81 offen lds
    s_add_u32 m0, s75, 1024
    s_add_u32 s81, s76, 10240
    buffer_load_dwordx4 v3, s[32:35], s81 offen lds
    s_add_u32 m0, s75, 2048
    s_add_u32 s81, s76, 20480
    buffer_load_dwordx4 v2, s[32:35], s81 offen lds
    s_add_u32 m0, s75, 3072
    s_add_u32 s81, s76, 30720
    buffer_load_dwordx4 v3, s[32:35], s81 offen lds
    s_add_u32 m0, s74, s64
    s_nop 0
    buffer_load_dwordx4 v8, s[36:39], s69 offen lds
    s_add_u32 m0, s74, s65
    s_nop 0
    buffer_load_dwordx4 v9, s[40:43], s69 offen lds
    s_add_u32 m0, s74, s66
    s_nop 0
    buffer_load_dwordx4 v10, s[44:47], s69 offen lds
    s_add_u32 s74, s74, 12288
    s_cmp_ge_u32 s74, 159744
    s_cselect_b32 s74, 98304, s74
    s_add_u32 s69, s69, s68
    s_waitcnt vmcnt(22)
    s_barrier
    s_add_u32 m0, s75, 16384
    s_add_u32 s81, s76, 163840
    buffer_load_dwordx4 v2, s[32:35], s81 offen lds
    s_add_u32 m0, s75, 17408
    s_add_u32 s81, s76, 174080
    buffer_load_dwordx4 v3, s[32:35], s81 offen lds
    s_add_u32 m0, s75, 18432
    s_add_u32 s81, s76, 184320
    buffer_load_dwordx4 v2, s[32:35], s81 offen lds
    s_add_u32 m0, s75, 19456
    s_add_u32 s81, s76, 194560
    buffer_load_dwordx4 v3, s[32:35], s81 offen lds
    s_add_u32 s75, s75, 32768
    s_sub_u32 s79, s75, 98304
    s_cmp_ge_u32 s75, s77
    s_cselect_b32 s75, s79, s75
    s_add_u32 s76, s76, 128
    s_add_u32 m0, s74, s64
    s_nop 0
    buffer_load_dwordx4 v8, s[36:39], s69 offen lds
    s_add_u32 m0, s74, s65
    s_nop 0
    buffer_load_dwordx4 v9, s[40:43], s69 offen lds
    s_add_u32 m0, s74, s66
    s_nop 0
    buffer_load_dwordx4 v10, s[44:47], s69 offen lds
    s_add_u32 s74, s74, 12288
    s_cmp_ge_u32 s74, 159744
    s_cselect_b32 s74, 98304, s74
    s_add_u32 s69, s69, s68
    s_waitcnt vmcnt(17)
    s_barrier
    s_add_u32 m0, s75, 0
    s_add_u32 s81, s76, 0
    buffer_load_dwordx4 v2, s[32:35], s81 offen lds
    s_add_u32 m0, s75, 1024
    s_add_u32 s81, s76, 10240
    buffer_load_dwordx4 v3, s[32:35], s81 offen lds
    s_add_u32 m0, s75, 2048
    s_add_u32 s81, s76, 20480
    buffer_load_dwordx4 v2, s[32:35], s81 offen lds
    s_add_u32 m0, s75, 3072
    s_add_u32 s81, s76, 30720
    buffer_load_dwordx4 v3, s[32:35], s81 offen lds
    s_add_u32 m0, s74, s64
    s_nop 0
    buffer_load_dwordx4 v8, s[36:39], s69 offen lds
    s_add_u32 m0, s74, s65
    s_nop 0
    buffer_load_dwordx4 v9, s[40:43], s69 offen lds
    s_add_u32 m0, s74, s66
    s_nop 0
    buffer_load_dwordx4 v10, s[44:47], s69 offen lds
    s_add_u32 s74, s74, 12288
    s_cmp_ge_u32 s74, 159744
    s_cselect_b32 s74, 98304, s74
    s_add_u32 s69, s69, s68
    s_waitcnt vmcnt(21)
    s_barrier
    s_add_u32 m0, s75, 16384
    s_add_u32 s81, s76, 163840
    buffer_load_dwordx4 v2, s[32:35], s81 offen lds
    s_add_u32 m0, s75, 17408
    s_add_u32 s81, s76, 174080
    buffer_load_dwordx4 v3, s[32:35], s81 offen lds
    s_add_u32 m0, s75, 18432
    s_add_u32 s81, s76, 184320
    buffer_load_dwordx4 v2, s[32:35], s81 offen lds
    s_add_u32 m0, s75, 19456
    s_add_u32 s81, s76, 194560
    buffer_load_dwordx4 v3, s[32:35], s81 offen lds
    s_add_u32 s75, s75, 32768
    s_sub_u32 s79, s75, 98304
    s_cmp_ge_u32 s75, s77
    s_cselect_b32 s75, s79, s75
    s_add_u32 s76, s76, 128
    s_add_u32 m0, s74, s64
    s_nop 0
    buffer_load_dwordx4 v8, s[36:39], s69 offen lds
    s_add_u32 m0, s74, s65
    s_nop 0
    buffer_load_dwordx4 v9, s[40:43], s69 offen lds
    s_add_u32 m0, s74, s66
    s_nop 0
    buffer_load_dwordx4 v10, s[44:47], s69 offen lds
    s_add_u32 s74, s74, 12288
    s_cmp_ge_u32 s74, 159744
    s_cselect_b32 s74, 98304, s74
    s_add_u32 s69, s69, s68
    s_waitcnt vmcnt(17)
    s_barrier
    s_add_u32 m0, s75, 0
    s_add_u32 s81, s76, 0
    buffer_load_dwordx4 v2, s[32:35], s81 offen lds
    s_add_u32 m0, s75, 1024
    s_add_u32 s81, s76, 10240
    buffer_load_dwordx4 v3, s[32:35], s81 offen lds
    s_add_u32 m0, s75, 2048
    s_add_u32 s81, s76, 20480
    buffer_load_dwordx4 v2, s[32:35], s81 offen lds
    s_add_u32 m0, s75, 3072
    s_add_u32 s81, s76, 30720
    buffer_load_dwordx4 v3, s[32:35], s81 offen lds
    s_add_u32 m0, s74, s64
    s_nop 0
    buffer_load_dwordx4 v8, s[36:39], s69 offen lds
    s_add_u32 m0, s74, s65
    s_nop 0
    buffer_load_dwordx4 v9, s[40:43], s69 offen lds
    s_add_u32 m0, s74, s66
    s_nop 0
    buffer_load_dwordx4 v10, s[44:47], s69 offen lds
    s_add_u32 s74, s74, 12288
    s_cmp_ge_u32 s74, 159744
    s_cselect_b32 s74, 98304, s74
    s_add_u32 s69, s69, s68
    s_waitcnt vmcnt(21)
    s_barrier
    s_add_u32 m0, s75, 16384
    s_add_u32 s81, s76, 163840
    buffer_load_dwordx4 v2, s[32:35], s81 offen lds
    s_add_u32 m0, s75, 17408
    s_add_u32 s81, s76, 174080
    buffer_load_dwordx4 v3, s[32:35], s81 offen lds
    s_add_u32 m0, s75, 18432
    s_add_u32 s81, s76, 184320
    buffer_load_dwordx4 v2, s[32:35], s81 offen lds
    s_add_u32 m0, s75, 19456
    s_add_u32 s81, s76, 194560
    buffer_load_dwordx4 v3, s[32:35], s81 offen lds
    s_add_u32 s75, s75, 32768
    s_sub_u32 s79, s75, 98304
    s_cmp_ge_u32 s75, s77
    s_cselect_b32 s75, s79, s75
    s_add_u32 s76, s76, 128
    s_add_u32 m0, s74, s64
    s_nop 0
    buffer_load_dwordx4 v8, s[36:39], s69 offen lds
    s_add_u32 m0, s74, s65
    s_nop 0
    buffer_load_dwordx4 v9, s[40:43], s69 offen lds
    s_add_u32 m0, s74, s66
    s_nop 0
    buffer_load_dwordx4 v10, s[44:47], s69 offen lds
    s_add_u32 s74, s74, 12288
    s_cmp_ge_u32 s74, 159744
    s_cselect_b32 s74, 98304, s74
    s_add_u32 s69, s69, s68
    s_waitcnt vmcnt(17)
    s_barrier
    s_add_u32 m0, s75, 0
    s_add_u32 s81, s76, 0
    buffer_load_dwordx4 v2, s[32:35], s81 offen lds
    s_add_u32 m0, s75, 1024
    s_add_u32 s81, s76, 10240
    buffer_load_dwordx4 v3, s[32:35], s81 offen lds
    s_add_u32 m0, s75, 2048
    s_add_u32 s81, s76, 20480
    buffer_load_dwordx4 v2, s[32:35], s81 offen lds
    s_add_u32 m0, s75, 3072
    s_add_u32 s81, s76, 30720
    buffer_load_dwordx4 v3, s[32:35], s81 offen lds
    s_add_u32 m0, s74, s64
    s_nop 0
    buffer_load_dwordx4 v8, s[36:39], s69 offen lds
    s_add_u32 m0, s74, s65
    s_nop 0
    buffer_load_dwordx4 v9, s[40:43], s69 offen lds
    s_add_u32 m0, s74, s66
    s_nop 0
    buffer_load_dwordx4 v10, s[44:47], s69 offen lds
    s_add_u32 s74, s74, 12288
    s_cmp_ge_u32 s74, 159744
    s_cselect_b32 s74, 98304, s74
    s_add_u32 s69, s69, s68
    s_cmp_ge_u32 s30, 2
    s_cbranch_scc1 K1_CPF2_DONE
    s_getpc_b64 s[82:83]
K1_CPF2_PC:
    s_sub_u32 s82, s82, K1_CPF2_PC-parallel_sum__linear_attn_block__geglu_ffn__prompt_kernel
    s_subb_u32 s83, s83, 0
    s_lshl_b32 s73, s30, 2
    s_add_u32 s73, s73, s60
    s_lshl_b32 s73, s73, 13
    v_lshlrev_b32 v36, 7, v0
    v_add_u32 v36, s73, v36
    v_min_u32 v38, K1_END-parallel_sum__linear_attn_block__geglu_ffn__prompt_kernel, v36
    v_mov_b32 v39, s83
    v_add_co_u32 v38, vcc, s82, v38
    s_nop 1
    v_addc_co_u32 v39, vcc, 0, v39, vcc
    global_load_dword v1, v[38:39], off
K1_CPF2_DONE:
    s_waitcnt vmcnt(21)
    s_barrier
    s_add_u32 m0, s75, 16384
    s_add_u32 s81, s76, 163840
    buffer_load_dwordx4 v2, s[32:35], s81 offen lds
    s_add_u32 m0, s75, 17408
    s_add_u32 s81, s76, 174080
    buffer_load_dwordx4 v3, s[32:35], s81 offen lds
    s_add_u32 m0, s75, 18432
    s_add_u32 s81, s76, 184320
    buffer_load_dwordx4 v2, s[32:35], s81 offen lds
    s_add_u32 m0, s75, 19456
    s_add_u32 s81, s76, 194560
    buffer_load_dwordx4 v3, s[32:35], s81 offen lds
    s_add_u32 s75, s75, 32768
    s_sub_u32 s79, s75, 98304
    s_cmp_ge_u32 s75, s77
    s_cselect_b32 s75, s79, s75
    s_add_u32 s76, s76, 128
    s_add_u32 m0, s74, s64
    s_nop 0
    buffer_load_dwordx4 v8, s[36:39], s69 offen lds
    s_add_u32 m0, s74, s65
    s_nop 0
    buffer_load_dwordx4 v9, s[40:43], s69 offen lds
    s_add_u32 m0, s74, s66
    s_nop 0
    buffer_load_dwordx4 v10, s[44:47], s69 offen lds
    s_add_u32 s74, s74, 12288
    s_cmp_ge_u32 s74, 159744
    s_cselect_b32 s74, 98304, s74
    s_add_u32 s69, s69, s68
    s_waitcnt vmcnt(17)
    s_barrier
    v_lshlrev_b32 v16, 3, v16
    v_lshlrev_b32 v15, 5, v0
    s_mov_b32 s63, 0
    s_cmp_eq_u32 s60, 3
    s_cbranch_scc1 K1_LD_ROWS
    s_mov_b32 s62, 13860864
    buffer_load_dwordx2 v[20:21], v16, s[48:51], s62 offen sc1
    s_mov_b32 s62, 13903872
    buffer_load_dwordx2 v[22:23], v16, s[48:51], s62 offen sc1
    s_mov_b32 s62, 13946880
    buffer_load_dwordx2 v[24:25], v16, s[48:51], s62 offen sc1
    s_mov_b32 s62, 13989888
    buffer_load_dwordx2 v[26:27], v16, s[48:51], s62 offen sc1
    s_mov_b32 s62, 14032896
    buffer_load_dwordx2 v[28:29], v16, s[48:51], s62 offen sc1
    s_mov_b32 s62, 14075904
    buffer_load_dwordx2 v[30:31], v16, s[48:51], s62 offen sc1
    s_mov_b32 s62, 14118912
    buffer_load_dwordx2 v[32:33], v16, s[48:51], s62 offen sc1
    s_mov_b32 s62, 14161920
    buffer_load_dwordx2 v[34:35], v16, s[48:51], s62 offen sc1
    s_waitcnt vmcnt(22)
    s_barrier
    s_waitcnt vmcnt(8)
    s_barrier
K1_LD_CCHK:
    s_waitcnt vmcnt(0)
    v_xor_b32 v14, v13, v21
    v_xor_b32 v12, v13, v23
    v_or_b32 v14, v14, v12
    v_xor_b32 v12, v13, v25
    v_or_b32 v14, v14, v12
    v_xor_b32 v12, v13, v27
    v_or_b32 v14, v14, v12
    v_xor_b32 v12, v13, v29
    v_or_b32 v14, v14, v12
    v_xor_b32 v12, v13, v31
    v_or_b32 v14, v14, v12
    v_xor_b32 v12, v13, v33
    v_or_b32 v14, v14, v12
    v_xor_b32 v12, v13, v35
    v_or_b32 v14, v14, v12
    v_cmp_ne_u32 vcc, 0, v14
    s_nop 1
    s_cmp_eq_u64 vcc, 0
    s_cbranch_scc1 K1_LD_COK
    s_add_u32 s63, s63, 1
    s_cmp_gt_u32 s63, 200000
    s_cbranch_scc1 K1_LD_COK
    s_sleep 8
    s_mov_b32 s62, 13860864
    buffer_load_dwordx2 v[20:21], v16, s[48:51], s62 offen sc1
    s_mov_b32 s62, 13903872
    buffer_load_dwordx2 v[22:23], v16, s[48:51], s62 offen sc1
    s_mov_b32 s62, 13946880
    buffer_load_dwordx2 v[24:25], v16, s[48:51], s62 offen sc1
    s_mov_b32 s62, 13989888
    buffer_load_dwordx2 v[26:27], v16, s[48:51], s62 offen sc1
    s_mov_b32 s62, 14032896
    buffer_load_dwordx2 v[28:29], v16, s[48:51], s62 offen sc1
    s_mov_b32 s62, 14075904
    buffer_load_dwordx2 v[30:31], v16, s[48:51], s62 offen sc1
    s_mov_b32 s62, 14118912
    buffer_load_dwordx2 v[32:33], v16, s[48:51], s62 offen sc1
    s_mov_b32 s62, 14161920
    buffer_load_dwordx2 v[34:35], v16, s[48:51], s62 offen sc1
    s_branch K1_LD_CCHK
K1_LD_COK:
    v_add_f32 v20, v20, v22
    v_add_f32 v24, v24, v26
    v_add_f32 v28, v28, v30
    v_add_f32 v32, v32, v34
    v_add_f32 v20, v20, v24
    v_add_f32 v28, v28, v32
    v_add_f32 v20, v20, v28
    v_cvt_pk_bf16_f32 v21, v20, v20
    v_and_b32 v21, 0xffff0000, v21
    v_sub_f32 v22, v20, v21
    v_cvt_pk_bf16_f32 v20, v21, v22
    v_lshlrev_b32 v17, 2, v17
    v_add_u32 v17, 161792, v17
    ds_write_b32 v17, v20
    s_branch K1_LD_FIN
K1_LD_ROWS:
    s_lshl_b32 s62, s25, 11
    s_add_u32 s62, s62, 13844480
    buffer_load_dwordx2 v[20:21], v15, s[48:51], s62 offen offset:0 sc1
    buffer_load_dwordx2 v[22:23], v15, s[48:51], s62 offen offset:8 sc1
    buffer_load_dwordx2 v[24:25], v15, s[48:51], s62 offen offset:16 sc1
    buffer_load_dwordx2 v[26:27], v15, s[48:51], s62 offen offset:24 sc1
    s_waitcnt vmcnt(18)
    s_barrier
    s_waitcnt vmcnt(4)
    s_barrier
K1_LD_RCHK:
    s_waitcnt vmcnt(0)
    v_xor_b32 v14, v13, v21
    v_xor_b32 v12, v13, v23
    v_or_b32 v14, v14, v12
    v_xor_b32 v12, v13, v25
    v_or_b32 v14, v14, v12
    v_xor_b32 v12, v13, v27
    v_or_b32 v14, v14, v12
    v_cmp_ne_u32 vcc, 0, v14
    s_nop 1
    s_cmp_eq_u64 vcc, 0
    s_cbranch_scc1 K1_LD_ROK
    s_add_u32 s63, s63, 1
    s_cmp_gt_u32 s63, 200000
    s_cbranch_scc1 K1_LD_ROK
    s_sleep 8
    buffer_load_dwordx2 v[20:21], v15, s[48:51], s62 offen offset:0 sc1
    buffer_load_dwordx2 v[22:23], v15, s[48:51], s62 offen offset:8 sc1
    buffer_load_dwordx2 v[24:25], v15, s[48:51], s62 offen offset:16 sc1
    buffer_load_dwordx2 v[26:27], v15, s[48:51], s62 offen offset:24 sc1
    s_branch K1_LD_RCHK
K1_LD_ROK:
    v_lshrrev_b32 v15, 1, v15
    v_add_u32 v15, 159744, v15
    v_and_b32 v28, 0xffff, v20
    v_lshl_or_b32 v28, v28, 16, v28
    v_and_b32 v32, 0xffff0000, v20
    v_rcp_f32 v32, v32
    v_and_b32 v29, 0xffff, v22
    v_lshl_or_b32 v29, v29, 16, v29
    v_and_b32 v33, 0xffff0000, v22
    v_rcp_f32 v33, v33
    v_and_b32 v30, 0xffff, v24
    v_lshl_or_b32 v30, v30, 16, v30
    v_and_b32 v34, 0xffff0000, v24
    v_rcp_f32 v34, v34
    v_and_b32 v31, 0xffff, v26
    v_lshl_or_b32 v31, v31, 16, v31
    v_and_b32 v35, 0xffff0000, v26
    v_rcp_f32 v35, v35
    s_nop 0
    ds_write_b128 v15, v[28:31]
    ds_write_b128 v15, v[32:35] offset:1024
K1_LD_FIN:
    s_waitcnt lgkmcnt(0)
    s_barrier
    s_and_b32 s72, s2, 7
    s_lshr_b32 s73, s2, 3
    s_and_b32 s74, s72, 3
    s_lshl_b32 s74, s74, 3
    s_and_b32 s75, s73, 7
    s_add_u32 s61, s74, s75
    s_lshr_b32 s74, s72, 2
    s_lshl_b32 s74, s74, 2
    s_lshr_b32 s75, s73, 3
    s_add_u32 s62, s74, s75
    v_lshlrev_b32 v6, 4, v0
    s_xor_b32 s72, s60, 0
    s_lshl_b32 s72, s72, 10
    v_add_u32 v2, s72, v6
    s_xor_b32 s72, s60, 1
    s_lshl_b32 s72, s72, 10
    v_add_u32 v3, s72, v6
    s_xor_b32 s72, s60, 2
    s_lshl_b32 s72, s72, 10
    v_add_u32 v4, s72, v6
    s_xor_b32 s72, s60, 3
    s_lshl_b32 s72, s72, 10
    v_add_u32 v5, s72, v6
    s_and_b32 s72, s60, 1
    s_lshl_b32 s72, s72, 8
    v_xor_b32 v11, s72, v6
    s_lshr_b32 s72, s60, 1
    s_lshl_b32 s73, s72, 10
    v_add_u32 v7, s73, v11
    s_xor_b32 s73, s73, 1024
    v_add_u32 v8, s73, v11
    s_mul_i32 s63, s61, 221184
    s_mul_i32 s64, s62, 378880
    s_add_u32 s64, s64, 9699328
    s_mul_i32 s72, s60, 25600
    s_add_u32 s67, s64, s72
    s_add_u32 s67, s67, 276480
    s_and_b32 s72, s60, 1
    s_add_u32 s72, s72, 52
    s_lshl_b32 s73, s72, 12
    s_add_u32 s68, s63, s73
    s_mul_i32 s73, s72, 5120
    s_add_u32 s69, s64, s73
    s_mul_i32 s72, s60, 53248
    s_add_u32 s63, s63, s72
    s_mul_i32 s72, s60, 66560
    s_add_u32 s64, s64, s72
    s_mul_i32 s65, s61, 81920
    s_mul_i32 s72, s60, 20480
    s_add_u32 s65, s65, s72
    s_add_u32 s65, s65, 7077888
    s_lshl_b32 s66, s60, 14
    s_add_u32 s66, s66, 13778944
    v_and_b32 v11, 15, v0
    v_mul_u32_u24 v9, 1280, v11
    v_lshrrev_b32 v11, 4, v0
    v_lshl_add_u32 v9, v11, 3, v9
    s_lshl_b32 s72, s61, 2
    s_add_u32 s72, s72, s60
    s_mul_i32 s72, s72, 20480
    s_mul_i32 s73, s62, 160
    s_add_u32 s70, s72, s73
    s_mul_i32 s71, s60, 39936
    v_add_u32 v10, s71, v6
    s_mov_b32 s36, s18
    s_and_b32 s37, s19, 0xffff
    s_mov_b32 s38, 2621440
    s_mov_b32 s39, 0x20000
    v_add_u32 v2, s71, v2
    v_add_u32 v3, s71, v3
    v_add_u32 v4, s71, v4
    v_add_u32 v5, s71, v5
    v_add_u32 v7, s71, v7
    v_add_u32 v8, s71, v8
    s_barrier
    s_setprio 0
    s_mov_b32 s79, 1
    s_cmp_ge_u32 s26, 22
    s_cbranch_scc1 P2_KVWG
    s_mov_b32 s73, 14237696
    v_lshlrev_b32 v14, 7, v0
    buffer_load_dword v12, v14, s[48:51], s73 offen sc1
    s_waitcnt vmcnt(0)
    v_cmp_ne_u32 vcc, v12, v13
    s_nop 1
    s_and_b32 s72, vcc_lo, 0xffff
    s_cbranch_scc1 P2_B20
    s_add_u32 m0, s71, 0
    s_add_u32 s72, s64, 0
    buffer_load_dwordx4 v6, s[48:51], s72 offen offset:0 sc1 lds
    buffer_load_dwordx4 v6, s[48:51], s72 offen offset:1024 sc1 lds
    buffer_load_dwordx4 v6, s[48:51], s72 offen offset:2048 sc1 lds
    buffer_load_dwordx4 v6, s[48:51], s72 offen offset:3072 sc1 lds
    s_add_u32 m0, s71, 4096
    s_add_u32 s72, s64, 4096
    buffer_load_dwordx4 v6, s[48:51], s72 offen offset:0 sc1 lds
    s_add_u32 m0, s71, 5120
    s_add_u32 s72, s64, 5120
    buffer_load_dwordx4 v6, s[48:51], s72 offen offset:0 sc1 lds
    buffer_load_dwordx4 v6, s[48:51], s72 offen offset:1024 sc1 lds
    buffer_load_dwordx4 v6, s[48:51], s72 offen offset:2048 sc1 lds
    buffer_load_dwordx4 v6, s[48:51], s72 offen offset:3072 sc1 lds
    s_add_u32 m0, s71, 9216
    s_add_u32 s72, s64, 9216
    buffer_load_dwordx4 v6, s[48:51], s72 offen offset:0 sc1 lds
    s_add_u32 m0, s71, 10240
    s_add_u32 s72, s64, 10240
    buffer_load_dwordx4 v6, s[48:51], s72 offen offset:0 sc1 lds
    buffer_load_dwordx4 v6, s[48:51], s72 offen offset:1024 sc1 lds
    buffer_load_dwordx4 v6, s[48:51], s72 offen offset:2048 sc1 lds
    buffer_load_dwordx4 v6, s[48:51], s72 offen offset:3072 sc1 lds
    s_add_u32 m0, s71, 14336
    s_add_u32 s72, s64, 14336
    buffer_load_dwordx4 v6, s[48:51], s72 offen offset:0 sc1 lds
    s_add_u32 m0, s71, 15360
    s_add_u32 s72, s64, 15360
    buffer_load_dwordx4 v6, s[48:51], s72 offen offset:0 sc1 lds
    buffer_load_dwordx4 v6, s[48:51], s72 offen offset:1024 sc1 lds
    buffer_load_dwordx4 v6, s[48:51], s72 offen offset:2048 sc1 lds
    buffer_load_dwordx4 v6, s[48:51], s72 offen offset:3072 sc1 lds
    s_add_u32 m0, s71, 19456
    s_add_u32 s72, s64, 19456
    buffer_load_dwordx4 v6, s[48:51], s72 offen offset:0 sc1 lds
    s_add_u32 m0, s71, 20480
    s_add_u32 s72, s64, 20480
    buffer_load_dwordx4 v6, s[48:51], s72 offen offset:0 sc1 lds
    buffer_load_dwordx4 v6, s[48:51], s72 offen offset:1024 sc1 lds
    buffer_load_dwordx4 v6, s[48:51], s72 offen offset:2048 sc1 lds
    buffer_load_dwordx4 v6, s[48:51], s72 offen offset:3072 sc1 lds
    s_add_u32 m0, s71, 24576
    s_add_u32 s72, s64, 24576
    buffer_load_dwordx4 v6, s[48:51], s72 offen offset:0 sc1 lds
    s_mov_b32 s79, 0
    s_branch P2_B20
P2_KVWG:
    s_barrier
P2_B20:
    s_barrier
    s_cmp_lg_u32 s60, 0
    s_cbranch_scc1 P2_ENTRY
    s_lshl_b32 s72, s25, 5
    s_add_u32 s72, s72, s26
    s_lshl_b32 s72, s72, 7
    s_add_u32 s72, s72, 14204928
    s_mov_b64 exec, 1
    buffer_store_dword v13, off, s[48:51], s72 sc0 sc1
    s_mov_b64 exec, -1
P2_ENTRY:
    s_cmp_eq_u32 s79, 0
    s_cbranch_scc1 P2_PRE_DONE
    s_mov_b32 s73, 14237696
    v_lshlrev_b32 v14, 7, v0
    s_mov_b32 s76, 0xffff
    s_mov_b32 s77, 0
    s_mov_b32 s78, 0
    s_mov_b64 exec, s[76:77]
P2_POLL_PK2:
    buffer_load_dword v12, v14, s[48:51], s73 offen sc1
    s_waitcnt vmcnt(0)
    v_cmp_ne_u32 vcc, v12, v13
    s_cbranch_vccz P2_OK_PK2
    s_add_u32 s78, s78, 1
    s_cmp_gt_u32 s78, 100000
    s_cbranch_scc1 P2_OK_PK2
    s_sleep 4
    s_branch P2_POLL_PK2
P2_OK_PK2:
    s_mov_b64 exec, -1
    s_add_u32 m0, s71, 0
    s_add_u32 s72, s64, 0
    buffer_load_dwordx4 v6, s[48:51], s72 offen offset:0 sc1 lds
    buffer_load_dwordx4 v6, s[48:51], s72 offen offset:1024 sc1 lds
    buffer_load_dwordx4 v6, s[48:51], s72 offen offset:2048 sc1 lds
    buffer_load_dwordx4 v6, s[48:51], s72 offen offset:3072 sc1 lds
    s_add_u32 m0, s71, 4096
    s_add_u32 s72, s64, 4096
    buffer_load_dwordx4 v6, s[48:51], s72 offen offset:0 sc1 lds
    s_add_u32 m0, s71, 5120
    s_add_u32 s72, s64, 5120
    buffer_load_dwordx4 v6, s[48:51], s72 offen offset:0 sc1 lds
    buffer_load_dwordx4 v6, s[48:51], s72 offen offset:1024 sc1 lds
    buffer_load_dwordx4 v6, s[48:51], s72 offen offset:2048 sc1 lds
    buffer_load_dwordx4 v6, s[48:51], s72 offen offset:3072 sc1 lds
    s_add_u32 m0, s71, 9216
    s_add_u32 s72, s64, 9216
    buffer_load_dwordx4 v6, s[48:51], s72 offen offset:0 sc1 lds
    s_add_u32 m0, s71, 10240
    s_add_u32 s72, s64, 10240
    buffer_load_dwordx4 v6, s[48:51], s72 offen offset:0 sc1 lds
    buffer_load_dwordx4 v6, s[48:51], s72 offen offset:1024 sc1 lds
    buffer_load_dwordx4 v6, s[48:51], s72 offen offset:2048 sc1 lds
    buffer_load_dwordx4 v6, s[48:51], s72 offen offset:3072 sc1 lds
    s_add_u32 m0, s71, 14336
    s_add_u32 s72, s64, 14336
    buffer_load_dwordx4 v6, s[48:51], s72 offen offset:0 sc1 lds
    s_add_u32 m0, s71, 15360
    s_add_u32 s72, s64, 15360
    buffer_load_dwordx4 v6, s[48:51], s72 offen offset:0 sc1 lds
    buffer_load_dwordx4 v6, s[48:51], s72 offen offset:1024 sc1 lds
    buffer_load_dwordx4 v6, s[48:51], s72 offen offset:2048 sc1 lds
    buffer_load_dwordx4 v6, s[48:51], s72 offen offset:3072 sc1 lds
    s_add_u32 m0, s71, 19456
    s_add_u32 s72, s64, 19456
    buffer_load_dwordx4 v6, s[48:51], s72 offen offset:0 sc1 lds
    s_add_u32 m0, s71, 20480
    s_add_u32 s72, s64, 20480
    buffer_load_dwordx4 v6, s[48:51], s72 offen offset:0 sc1 lds
    buffer_load_dwordx4 v6, s[48:51], s72 offen offset:1024 sc1 lds
    buffer_load_dwordx4 v6, s[48:51], s72 offen offset:2048 sc1 lds
    buffer_load_dwordx4 v6, s[48:51], s72 offen offset:3072 sc1 lds
    s_add_u32 m0, s71, 24576
    s_add_u32 s72, s64, 24576
    buffer_load_dwordx4 v6, s[48:51], s72 offen offset:0 sc1 lds
P2_PRE_DONE:
    s_cmp_ge_u32 s2, 64
    s_cbranch_scc1 P2_NORED
    s_cmp_lg_u32 s60, 1
    s_cbranch_scc1 P2_NORED
    s_lshr_b32 s72, s2, 3
    s_add_u32 s72, s72, 22
    s_lshl_b32 s72, s72, 7
    s_add_u32 s73, s72, 14204928
    s_lshr_b32 s74, s2, 1
    s_and_b32 s74, s74, 3
    s_and_b32 s75, s2, 1
    s_add_u32 s75, s75, s74
    s_lshl_b32 s75, s75, 4
    s_mul_i32 s74, s74, 20
    s_sub_i32 s75, s75, s74
    v_lshrrev_b32 v36, 5, v0
    v_lshlrev_b32 v36, 2, v36
    v_add_u32 v36, s75, v36
    v_bfe_u32 v37, v0, 3, 2
    v_and_b32 v38, 3, v0
    v_lshl_add_u32 v37, v37, 2, v38
    v_cmp_ge_u32 s[80:81], 10, v37
    v_lshlrev_b32 v37, 5, v0
    v_mov_b32 v38, 1073741824
    v_cmp_gt_u32 vcc, 20, v36
    s_nop 1
    s_and_b64 vcc, vcc, s[80:81]
    v_cndmask_b32 v39, v38, v37, vcc
    v_add_u32 v36, 8, v36
    v_cmp_gt_u32 vcc, 20, v36
    s_nop 1
    s_and_b64 vcc, vcc, s[80:81]
    v_cndmask_b32 v40, v38, v37, vcc
    v_lshlrev_b32 v14, 12, v0
    s_mov_b32 s76, 0xff
    s_mov_b32 s77, 0
    s_mov_b32 s78, 0
    s_mov_b64 exec, s[76:77]
P2_POLL_KV:
    buffer_load_dword v12, v14, s[48:51], s73 offen sc1
    s_waitcnt vmcnt(0)
    v_cmp_ne_u32 vcc, v12, v13
    s_cbranch_vccz P2_OK_KV
    s_add_u32 s78, s78, 1
    s_cmp_gt_u32 s78, 100000
    s_cbranch_scc1 P2_OK_KV
    s_sleep 2
    s_branch P2_POLL_KV
P2_OK_KV:
    s_mov_b64 exec, -1
    s_lshl_b32 s72, s2, 11
    s_add_u32 s72, s72, 12730368
    buffer_load_dwordx4 v[96:99], v39, s[48:51], s72 offen sc1
    buffer_load_dwordx4 v[100:103], v40, s[48:51], s72 offen offset:16 sc1
    s_add_u32 s72, s72, 131072
    buffer_load_dwordx4 v[104:107], v39, s[48:51], s72 offen sc1
    buffer_load_dwordx4 v[108:111], v40, s[48:51], s72 offen offset:16 sc1
    s_add_u32 s72, s72, 131072
    buffer_load_dwordx4 v[112:115], v39, s[48:51], s72 offen sc1
    buffer_load_dwordx4 v[116:119], v40, s[48:51], s72 offen offset:16 sc1
    s_add_u32 s72, s72, 131072
    buffer_load_dwordx4 v[120:123], v39, s[48:51], s72 offen sc1
    buffer_load_dwordx4 v[124:127], v40, s[48:51], s72 offen offset:16 sc1
    s_add_u32 s72, s72, 131072
    buffer_load_dwordx4 v[128:131], v39, s[48:51], s72 offen sc1
    buffer_load_dwordx4 v[132:135], v40, s[48:51], s72 offen offset:16 sc1
    s_add_u32 s72, s72, 131072
    buffer_load_dwordx4 v[136:139], v39, s[48:51], s72 offen sc1
    buffer_load_dwordx4 v[140:143], v40, s[48:51], s72 offen offset:16 sc1
    s_add_u32 s72, s72, 131072
    buffer_load_dwordx4 v[144:147], v39, s[48:51], s72 offen sc1
    buffer_load_dwordx4 v[148:151], v40, s[48:51], s72 offen offset:16 sc1
    s_add_u32 s72, s72, 131072
    buffer_load_dwordx4 v[152:155], v39, s[48:51], s72 offen sc1
    buffer_load_dwordx4 v[156:159], v40, s[48:51], s72 offen offset:16 sc1
    s_add_u32 s72, s72, 131072
    s_waitcnt vmcnt(0)
    v_pk_add_f32 v[96:97], v[96:97], v[104:105]
    v_pk_add_f32 v[98:99], v[98:99], v[106:107]
    v_pk_add_f32 v[100:101], v[100:101], v[108:109]
    v_pk_add_f32 v[102:103], v[102:103], v[110:111]
    v_pk_add_f32 v[96:97], v[96:97], v[112:113]
    v_pk_add_f32 v[98:99], v[98:99], v[114:115]
    v_pk_add_f32 v[100:101], v[100:101], v[116:117]
    v_pk_add_f32 v[102:103], v[102:103], v[118:119]
    v_pk_add_f32 v[96:97], v[96:97], v[120:121]
    v_pk_add_f32 v[98:99], v[98:99], v[122:123]
    v_pk_add_f32 v[100:101], v[100:101], v[124:125]
    v_pk_add_f32 v[102:103], v[102:103], v[126:127]
    v_pk_add_f32 v[96:97], v[96:97], v[128:129]
    v_pk_add_f32 v[98:99], v[98:99], v[130:131]
    v_pk_add_f32 v[100:101], v[100:101], v[132:133]
    v_pk_add_f32 v[102:103], v[102:103], v[134:135]
    v_pk_add_f32 v[96:97], v[96:97], v[136:137]
    v_pk_add_f32 v[98:99], v[98:99], v[138:139]
    v_pk_add_f32 v[100:101], v[100:101], v[140:141]
    v_pk_add_f32 v[102:103], v[102:103], v[142:143]
    v_pk_add_f32 v[96:97], v[96:97], v[144:145]
    v_pk_add_f32 v[98:99], v[98:99], v[146:147]
    v_pk_add_f32 v[100:101], v[100:101], v[148:149]
    v_pk_add_f32 v[102:103], v[102:103], v[150:151]
    v_pk_add_f32 v[96:97], v[96:97], v[152:153]
    v_pk_add_f32 v[98:99], v[98:99], v[154:155]
    v_pk_add_f32 v[100:101], v[100:101], v[156:157]
    v_pk_add_f32 v[102:103], v[102:103], v[158:159]
    v_cvt_pk_bf16_f32 v104, v96, v97
    v_cvt_pk_bf16_f32 v105, v98, v99
    v_cvt_pk_bf16_f32 v106, v100, v101
    v_cvt_pk_bf16_f32 v107, v102, v103
    s_lshl_b32 s72, s2, 10
    s_add_u32 s72, s72, 13778944
    buffer_store_dwordx4 v[104:107], v6, s[48:51], s72 offen sc0 sc1
P2_NORED:
    s_nop 1
    s_cmp_lg_u32 s60, 0
    s_cbranch_scc1 P2_B21
    s_lshr_b32 s73, s61, 2
    s_lshl_b32 s73, s73, 12
    s_add_u32 s73, s73, 14204928
    v_lshlrev_b32 v14, 7, v0
    s_mov_b32 s76, 0x3fffff
    s_mov_b32 s77, 0
    s_mov_b32 s78, 0
    s_mov_b64 exec, s[76:77]
P2_POLL_MAIN:
    buffer_load_dword v12, v14, s[48:51], s73 offen sc1
    s_waitcnt vmcnt(0)
    v_cmp_ne_u32 vcc, v12, v13
    s_cbranch_vccz P2_OK_MAIN
    s_add_u32 s78, s78, 1
    s_cmp_gt_u32 s78, 100000
    s_cbranch_scc1 P2_OK_MAIN
    s_sleep 2
    s_branch P2_POLL_MAIN
P2_OK_MAIN:
    s_mov_b64 exec, -1
P2_B21:
    s_barrier
P2_GO:
    s_add_u32 m0, s71, 25600
    s_add_u32 s72, s63, 0
    buffer_load_dwordx4 v6, s[48:51], s72 offen offset:0 sc1 lds
    buffer_load_dwordx4 v6, s[48:51], s72 offen offset:1024 sc1 lds
    buffer_load_dwordx4 v6, s[48:51], s72 offen offset:2048 sc1 lds
    buffer_load_dwordx4 v6, s[48:51], s72 offen offset:3072 sc1 lds
    s_add_u32 m0, s71, 29696
    s_add_u32 s72, s63, 4096
    buffer_load_dwordx4 v6, s[48:51], s72 offen offset:0 sc1 lds
    buffer_load_dwordx4 v6, s[48:51], s72 offen offset:1024 sc1 lds
    buffer_load_dwordx4 v6, s[48:51], s72 offen offset:2048 sc1 lds
    buffer_load_dwordx4 v6, s[48:51], s72 offen offset:3072 sc1 lds
    s_add_u32 m0, s71, 33792
    s_add_u32 s72, s63, 8192
    buffer_load_dwordx4 v6, s[48:51], s72 offen offset:0 sc1 lds
    buffer_load_dwordx4 v6, s[48:51], s72 offen offset:1024 sc1 lds
    buffer_load_dwordx4 v6, s[48:51], s72 offen offset:2048 sc1 lds
    buffer_load_dwordx4 v6, s[48:51], s72 offen offset:3072 sc1 lds
    s_waitcnt vmcnt(8)
    ds_read_b128 v[128:131], v10 offset:0
    ds_read_b128 v[132:135], v2 offset:25600
    ds_read_b128 v[136:139], v3 offset:25600
    ds_read_b128 v[140:143], v4 offset:25600
    ds_read_b128 v[144:147], v5 offset:25600
    s_waitcnt lgkmcnt(0)
    v_mfma_f32_16x16x32_bf16 v[16:19], v[128:131], v[132:135], 0
    ds_read_b128 v[148:151], v10 offset:1024
    s_add_u32 m0, s71, 25600
    s_add_u32 s72, s63, 12288
    buffer_load_dwordx4 v6, s[48:51], s72 offen offset:0 sc1 lds
    v_mfma_f32_16x16x32_bf16 v[36:39], v[128:131], v[136:139], 0
    ds_read_b128 v[152:155], v10 offset:2048
    buffer_load_dwordx4 v6, s[48:51], s72 offen offset:1024 sc1 lds
    v_mfma_f32_16x16x32_bf16 v[56:59], v[128:131], v[140:143], 0
    ds_read_b128 v[156:159], v10 offset:3072
    buffer_load_dwordx4 v6, s[48:51], s72 offen offset:2048 sc1 lds
    v_mfma_f32_16x16x32_bf16 v[76:79], v[128:131], v[144:147], 0
    ds_read_b128 v[160:163], v10 offset:4096
    buffer_load_dwordx4 v6, s[48:51], s72 offen offset:3072 sc1 lds
    s_waitcnt lgkmcnt(3)
    v_mfma_f32_16x16x32_bf16 v[20:23], v[148:151], v[132:135], 0
    s_waitcnt vmcnt(8)
    ds_read_b128 v[164:167], v10 offset:5120
    v_mfma_f32_16x16x32_bf16 v[40:43], v[148:151], v[136:139], 0
    ds_read_b128 v[12:15], v2 offset:29696
    v_mfma_f32_16x16x32_bf16 v[60:63], v[148:151], v[140:143], 0
    ds_read_b128 v[96:99], v3 offset:29696
    v_mfma_f32_16x16x32_bf16 v[80:83], v[148:151], v[144:147], 0
    ds_read_b128 v[100:103], v4 offset:29696
    s_waitcnt lgkmcnt(6)
    v_mfma_f32_16x16x32_bf16 v[24:27], v[152:155], v[132:135], 0
    ds_read_b128 v[104:107], v5 offset:29696
    v_mfma_f32_16x16x32_bf16 v[44:47], v[152:155], v[136:139], 0
    ds_read_b128 v[108:111], v10 offset:6144
    v_mfma_f32_16x16x32_bf16 v[64:67], v[152:155], v[140:143], 0
    ds_read_b128 v[112:115], v10 offset:7168
    v_mfma_f32_16x16x32_bf16 v[84:87], v[152:155], v[144:147], 0
    ds_read_b128 v[116:119], v10 offset:8192
    s_waitcnt lgkmcnt(9)
    v_mfma_f32_16x16x32_bf16 v[28:31], v[156:159], v[132:135], 0
    ds_read_b128 v[120:123], v10 offset:9216
    v_mfma_f32_16x16x32_bf16 v[48:51], v[156:159], v[136:139], 0
    v_mfma_f32_16x16x32_bf16 v[68:71], v[156:159], v[140:143], 0
    v_mfma_f32_16x16x32_bf16 v[88:91], v[156:159], v[144:147], 0
    s_waitcnt lgkmcnt(9)
    v_mfma_f32_16x16x32_bf16 v[32:35], v[160:163], v[132:135], 0
    v_mfma_f32_16x16x32_bf16 v[52:55], v[160:163], v[136:139], 0
    s_add_u32 m0, s71, 0
    s_add_u32 s72, s63, 16384
    buffer_load_dwordx4 v6, s[48:51], s72 offen offset:0 sc1 lds
    v_mfma_f32_16x16x32_bf16 v[72:75], v[160:163], v[140:143], 0
    v_mfma_f32_16x16x32_bf16 v[92:95], v[160:163], v[144:147], 0
    buffer_load_dwordx4 v6, s[48:51], s72 offen offset:1024 sc1 lds
    s_waitcnt lgkmcnt(4)
    v_mfma_f32_16x16x32_bf16 v[16:19], v[164:167], v[12:15], v[16:19]
    buffer_load_dwordx4 v6, s[48:51], s72 offen offset:2048 sc1 lds
    v_mfma_f32_16x16x32_bf16 v[36:39], v[164:167], v[96:99], v[36:39]
    buffer_load_dwordx4 v6, s[48:51], s72 offen offset:3072 sc1 lds
    v_mfma_f32_16x16x32_bf16 v[56:59], v[164:167], v[100:103], v[56:59]
    v_mfma_f32_16x16x32_bf16 v[76:79], v[164:167], v[104:107], v[76:79]
    s_waitcnt lgkmcnt(3)
    v_mfma_f32_16x16x32_bf16 v[20:23], v[108:111], v[12:15], v[20:23]
    s_waitcnt vmcnt(8)
    ds_read_b128 v[124:127], v10 offset:10240
    v_mfma_f32_16x16x32_bf16 v[40:43], v[108:111], v[96:99], v[40:43]
    ds_read_b128 v[128:131], v2 offset:33792
    v_mfma_f32_16x16x32_bf16 v[60:63], v[108:111], v[100:103], v[60:63]
    ds_read_b128 v[148:151], v3 offset:33792
    v_mfma_f32_16x16x32_bf16 v[80:83], v[108:111], v[104:107], v[80:83]
    ds_read_b128 v[152:155], v4 offset:33792
    s_waitcnt lgkmcnt(6)
    v_mfma_f32_16x16x32_bf16 v[24:27], v[112:115], v[12:15], v[24:27]
    ds_read_b128 v[156:159], v5 offset:33792
    v_mfma_f32_16x16x32_bf16 v[44:47], v[112:115], v[96:99], v[44:47]
    ds_read_b128 v[132:135], v10 offset:11264
    v_mfma_f32_16x16x32_bf16 v[64:67], v[112:115], v[100:103], v[64:67]
    ds_read_b128 v[136:139], v10 offset:12288
    v_mfma_f32_16x16x32_bf16 v[84:87], v[112:115], v[104:107], v[84:87]
    ds_read_b128 v[140:143], v10 offset:13312
    s_waitcnt lgkmcnt(9)
    v_mfma_f32_16x16x32_bf16 v[28:31], v[116:119], v[12:15], v[28:31]
    ds_read_b128 v[160:163], v10 offset:14336
    v_mfma_f32_16x16x32_bf16 v[48:51], v[116:119], v[96:99], v[48:51]
    v_mfma_f32_16x16x32_bf16 v[68:71], v[116:119], v[100:103], v[68:71]
    v_mfma_f32_16x16x32_bf16 v[88:91], v[116:119], v[104:107], v[88:91]
    s_waitcnt lgkmcnt(9)
    v_mfma_f32_16x16x32_bf16 v[32:35], v[120:123], v[12:15], v[32:35]
    v_mfma_f32_16x16x32_bf16 v[52:55], v[120:123], v[96:99], v[52:55]
    s_add_u32 m0, s71, 4096
    s_add_u32 s72, s64, 25600
    buffer_load_dwordx4 v6, s[48:51], s72 offen offset:0 sc1 lds
    v_mfma_f32_16x16x32_bf16 v[72:75], v[120:123], v[100:103], v[72:75]
    v_mfma_f32_16x16x32_bf16 v[92:95], v[120:123], v[104:107], v[92:95]
    buffer_load_dwordx4 v6, s[48:51], s72 offen offset:1024 sc1 lds
    s_waitcnt lgkmcnt(4)
    v_mfma_f32_16x16x32_bf16 v[16:19], v[124:127], v[128:131], v[16:19]
    buffer_load_dwordx4 v6, s[48:51], s72 offen offset:2048 sc1 lds
    v_mfma_f32_16x16x32_bf16 v[36:39], v[124:127], v[148:151], v[36:39]
    buffer_load_dwordx4 v6, s[48:51], s72 offen offset:3072 sc1 lds
    v_mfma_f32_16x16x32_bf16 v[56:59], v[124:127], v[152:155], v[56:59]
    s_add_u32 m0, s71, 8192
    s_add_u32 s72, s64, 29696
    buffer_load_dwordx4 v6, s[48:51], s72 offen offset:0 sc1 lds
    v_mfma_f32_16x16x32_bf16 v[76:79], v[124:127], v[156:159], v[76:79]
    s_add_u32 m0, s71, 29696
    s_add_u32 s72, s63, 20480
    buffer_load_dwordx4 v6, s[48:51], s72 offen offset:0 sc1 lds
    s_waitcnt lgkmcnt(3)
    v_mfma_f32_16x16x32_bf16 v[20:23], v[132:135], v[128:131], v[20:23]
    s_waitcnt vmcnt(10)
    ds_read_b128 v[144:147], v10 offset:15360
    v_mfma_f32_16x16x32_bf16 v[40:43], v[132:135], v[148:151], v[40:43]
    ds_read_b128 v[164:167], v2 offset:25600
    buffer_load_dwordx4 v6, s[48:51], s72 offen offset:1024 sc1 lds
    v_mfma_f32_16x16x32_bf16 v[60:63], v[132:135], v[152:155], v[60:63]
    ds_read_b128 v[108:111], v3 offset:25600
    v_mfma_f32_16x16x32_bf16 v[80:83], v[132:135], v[156:159], v[80:83]
    ds_read_b128 v[112:115], v4 offset:25600
    buffer_load_dwordx4 v6, s[48:51], s72 offen offset:2048 sc1 lds
    s_waitcnt lgkmcnt(6)
    v_mfma_f32_16x16x32_bf16 v[24:27], v[136:139], v[128:131], v[24:27]
    ds_read_b128 v[116:119], v5 offset:25600
    v_mfma_f32_16x16x32_bf16 v[44:47], v[136:139], v[148:151], v[44:47]
    ds_read_b128 v[12:15], v10 offset:16384
    buffer_load_dwordx4 v6, s[48:51], s72 offen offset:3072 sc1 lds
    v_mfma_f32_16x16x32_bf16 v[64:67], v[136:139], v[152:155], v[64:67]
    ds_read_b128 v[96:99], v10 offset:17408
    v_mfma_f32_16x16x32_bf16 v[84:87], v[136:139], v[156:159], v[84:87]
    ds_read_b128 v[100:103], v10 offset:18432
    s_add_u32 m0, s71, 33792
    s_add_u32 s72, s64, 30720
    buffer_load_dwordx4 v6, s[48:51], s72 offen offset:0 sc1 lds
    s_waitcnt lgkmcnt(9)
    v_mfma_f32_16x16x32_bf16 v[28:31], v[140:143], v[128:131], v[28:31]
    ds_read_b128 v[120:123], v10 offset:19456
    v_mfma_f32_16x16x32_bf16 v[48:51], v[140:143], v[148:151], v[48:51]
    buffer_load_dwordx4 v6, s[48:51], s72 offen offset:1024 sc1 lds
    v_mfma_f32_16x16x32_bf16 v[68:71], v[140:143], v[152:155], v[68:71]
    v_mfma_f32_16x16x32_bf16 v[88:91], v[140:143], v[156:159], v[88:91]
    buffer_load_dwordx4 v6, s[48:51], s72 offen offset:2048 sc1 lds
    s_waitcnt lgkmcnt(9)
    v_mfma_f32_16x16x32_bf16 v[32:35], v[160:163], v[128:131], v[32:35]
    v_mfma_f32_16x16x32_bf16 v[52:55], v[160:163], v[148:151], v[52:55]
    buffer_load_dwordx4 v6, s[48:51], s72 offen offset:3072 sc1 lds
    v_mfma_f32_16x16x32_bf16 v[72:75], v[160:163], v[152:155], v[72:75]
    v_mfma_f32_16x16x32_bf16 v[92:95], v[160:163], v[156:159], v[92:95]
    s_add_u32 m0, s71, 37888
    s_add_u32 s72, s64, 34816
    buffer_load_dwordx4 v6, s[48:51], s72 offen offset:0 sc1 lds
    s_waitcnt lgkmcnt(4)
    v_mfma_f32_16x16x32_bf16 v[16:19], v[144:147], v[164:167], v[16:19]
    s_add_u32 m0, s71, 9216
    s_add_u32 s72, s63, 24576
    buffer_load_dwordx4 v6, s[48:51], s72 offen offset:0 sc1 lds
    v_mfma_f32_16x16x32_bf16 v[36:39], v[144:147], v[108:111], v[36:39]
    buffer_load_dwordx4 v6, s[48:51], s72 offen offset:1024 sc1 lds
    v_mfma_f32_16x16x32_bf16 v[56:59], v[144:147], v[112:115], v[56:59]
    buffer_load_dwordx4 v6, s[48:51], s72 offen offset:2048 sc1 lds
    v_mfma_f32_16x16x32_bf16 v[76:79], v[144:147], v[116:119], v[76:79]
    buffer_load_dwordx4 v6, s[48:51], s72 offen offset:3072 sc1 lds
    s_waitcnt lgkmcnt(3)
    v_mfma_f32_16x16x32_bf16 v[20:23], v[12:15], v[164:167], v[20:23]
    s_waitcnt vmcnt(18)
    ds_read_b128 v[104:107], v10 offset:20480
    v_mfma_f32_16x16x32_bf16 v[40:43], v[12:15], v[108:111], v[40:43]
    ds_read_b128 v[124:127], v2 offset:0
    v_mfma_f32_16x16x32_bf16 v[60:63], v[12:15], v[112:115], v[60:63]
    ds_read_b128 v[132:135], v3 offset:0
    v_mfma_f32_16x16x32_bf16 v[80:83], v[12:15], v[116:119], v[80:83]
    ds_read_b128 v[136:139], v4 offset:0
    s_waitcnt lgkmcnt(6)
    v_mfma_f32_16x16x32_bf16 v[24:27], v[96:99], v[164:167], v[24:27]
    ds_read_b128 v[140:143], v5 offset:0
    v_mfma_f32_16x16x32_bf16 v[44:47], v[96:99], v[108:111], v[44:47]
    ds_read_b128 v[128:131], v10 offset:21504
    v_mfma_f32_16x16x32_bf16 v[64:67], v[96:99], v[112:115], v[64:67]
    ds_read_b128 v[148:151], v10 offset:22528
    v_mfma_f32_16x16x32_bf16 v[84:87], v[96:99], v[116:119], v[84:87]
    ds_read_b128 v[152:155], v10 offset:23552
    s_waitcnt lgkmcnt(9)
    v_mfma_f32_16x16x32_bf16 v[28:31], v[100:103], v[164:167], v[28:31]
    ds_read_b128 v[160:163], v10 offset:24576
    v_mfma_f32_16x16x32_bf16 v[48:51], v[100:103], v[108:111], v[48:51]
    v_mfma_f32_16x16x32_bf16 v[68:71], v[100:103], v[112:115], v[68:71]
    v_mfma_f32_16x16x32_bf16 v[88:91], v[100:103], v[116:119], v[88:91]
    s_waitcnt lgkmcnt(9)
    v_mfma_f32_16x16x32_bf16 v[32:35], v[120:123], v[164:167], v[32:35]
    v_mfma_f32_16x16x32_bf16 v[52:55], v[120:123], v[108:111], v[52:55]
    s_add_u32 m0, s71, 13312
    s_add_u32 s72, s64, 35840
    buffer_load_dwordx4 v6, s[48:51], s72 offen offset:0 sc1 lds
    v_mfma_f32_16x16x32_bf16 v[72:75], v[120:123], v[112:115], v[72:75]
    v_mfma_f32_16x16x32_bf16 v[92:95], v[120:123], v[116:119], v[92:95]
    buffer_load_dwordx4 v6, s[48:51], s72 offen offset:1024 sc1 lds
    s_waitcnt lgkmcnt(4)
    v_mfma_f32_16x16x32_bf16 v[16:19], v[104:107], v[124:127], v[16:19]
    buffer_load_dwordx4 v6, s[48:51], s72 offen offset:2048 sc1 lds
    v_mfma_f32_16x16x32_bf16 v[36:39], v[104:107], v[132:135], v[36:39]
    buffer_load_dwordx4 v6, s[48:51], s72 offen offset:3072 sc1 lds
    v_mfma_f32_16x16x32_bf16 v[56:59], v[104:107], v[136:139], v[56:59]
    s_add_u32 m0, s71, 17408
    s_add_u32 s72, s64, 39936
    buffer_load_dwordx4 v6, s[48:51], s72 offen offset:0 sc1 lds
    v_mfma_f32_16x16x32_bf16 v[76:79], v[104:107], v[140:143], v[76:79]
    s_add_u32 m0, s71, 0
    s_add_u32 s72, s63, 28672
    buffer_load_dwordx4 v6, s[48:51], s72 offen offset:0 sc1 lds
    s_waitcnt lgkmcnt(3)
    v_mfma_f32_16x16x32_bf16 v[20:23], v[128:131], v[124:127], v[20:23]
    s_waitcnt vmcnt(15)
    ds_read_b128 v[156:159], v10 offset:4096
    v_mfma_f32_16x16x32_bf16 v[40:43], v[128:131], v[132:135], v[40:43]
    ds_read_b128 v[144:147], v2 offset:29696
    buffer_load_dwordx4 v6, s[48:51], s72 offen offset:1024 sc1 lds
    v_mfma_f32_16x16x32_bf16 v[60:63], v[128:131], v[136:139], v[60:63]
    ds_read_b128 v[12:15], v3 offset:29696
    v_mfma_f32_16x16x32_bf16 v[80:83], v[128:131], v[140:143], v[80:83]
    ds_read_b128 v[96:99], v4 offset:29696
    buffer_load_dwordx4 v6, s[48:51], s72 offen offset:2048 sc1 lds
    s_waitcnt lgkmcnt(6)
    v_mfma_f32_16x16x32_bf16 v[24:27], v[148:151], v[124:127], v[24:27]
    ds_read_b128 v[100:103], v5 offset:29696
    v_mfma_f32_16x16x32_bf16 v[44:47], v[148:151], v[132:135], v[44:47]
    ds_read_b128 v[164:167], v10 offset:5120
    buffer_load_dwordx4 v6, s[48:51], s72 offen offset:3072 sc1 lds
    v_mfma_f32_16x16x32_bf16 v[64:67], v[148:151], v[136:139], v[64:67]
    ds_read_b128 v[108:111], v10 offset:6144
    v_mfma_f32_16x16x32_bf16 v[84:87], v[148:151], v[140:143], v[84:87]
    ds_read_b128 v[112:115], v10 offset:7168
    s_add_u32 m0, s71, 25600
    s_add_u32 s72, s66, 0
    buffer_load_dwordx4 v6, s[48:51], s72 offen offset:0 sc1 lds
    s_waitcnt lgkmcnt(9)
    v_mfma_f32_16x16x32_bf16 v[28:31], v[152:155], v[124:127], v[28:31]
    ds_read_b128 v[120:123], v10 offset:8192
    v_mfma_f32_16x16x32_bf16 v[48:51], v[152:155], v[132:135], v[48:51]
    buffer_load_dwordx4 v6, s[48:51], s72 offen offset:1024 sc1 lds
    v_mfma_f32_16x16x32_bf16 v[68:71], v[152:155], v[136:139], v[68:71]
    v_mfma_f32_16x16x32_bf16 v[88:91], v[152:155], v[140:143], v[88:91]
    buffer_load_dwordx4 v6, s[48:51], s72 offen offset:2048 sc1 lds
    s_waitcnt lgkmcnt(9)
    v_mfma_f32_16x16x32_bf16 v[32:35], v[160:163], v[124:127], v[32:35]
    v_mfma_f32_16x16x32_bf16 v[52:55], v[160:163], v[132:135], v[52:55]
    buffer_load_dwordx4 v6, s[48:51], s72 offen offset:3072 sc1 lds
    v_mfma_f32_16x16x32_bf16 v[72:75], v[160:163], v[136:139], v[72:75]
    v_mfma_f32_16x16x32_bf16 v[92:95], v[160:163], v[140:143], v[92:95]
    s_add_u32 m0, s71, 18432
    s_add_u32 s72, s65, 0
    buffer_load_dwordx4 v6, s[48:51], s72 offen offset:0 sc1 lds
    s_waitcnt lgkmcnt(4)
    v_mfma_f32_16x16x32_bf16 v[16:19], v[156:159], v[144:147], v[16:19]
    buffer_load_dwordx4 v6, s[48:51], s72 offen offset:1024 sc1 lds
    v_mfma_f32_16x16x32_bf16 v[36:39], v[156:159], v[12:15], v[36:39]
    buffer_load_dwordx4 v6, s[48:51], s72 offen offset:2048 sc1 lds
    v_mfma_f32_16x16x32_bf16 v[56:59], v[156:159], v[96:99], v[56:59]
    buffer_load_dwordx4 v6, s[48:51], s72 offen offset:3072 sc1 lds
    v_mfma_f32_16x16x32_bf16 v[76:79], v[156:159], v[100:103], v[76:79]
    s_add_u32 m0, s71, 22528
    s_add_u32 s72, s65, 4096
    buffer_load_dwordx4 v6, s[48:51], s72 offen offset:0 sc1 lds
    s_waitcnt lgkmcnt(3)
    v_mfma_f32_16x16x32_bf16 v[20:23], v[164:167], v[144:147], v[20:23]
    s_waitcnt vmcnt(18)
    ds_read_b128 v[116:119], v10 offset:33792
    v_mfma_f32_16x16x32_bf16 v[40:43], v[164:167], v[12:15], v[40:43]
    ds_read_b128 v[104:107], v2 offset:9216
    buffer_load_dwordx4 v6, s[48:51], s72 offen offset:1024 sc1 lds
    v_mfma_f32_16x16x32_bf16 v[60:63], v[164:167], v[96:99], v[60:63]
    ds_read_b128 v[128:131], v3 offset:9216
    v_mfma_f32_16x16x32_bf16 v[80:83], v[164:167], v[100:103], v[80:83]
    ds_read_b128 v[148:151], v4 offset:9216
    s_waitcnt lgkmcnt(6)
    v_mfma_f32_16x16x32_bf16 v[24:27], v[108:111], v[144:147], v[24:27]
    ds_read_b128 v[152:155], v5 offset:9216
    v_mfma_f32_16x16x32_bf16 v[44:47], v[108:111], v[12:15], v[44:47]
    ds_read_b128 v[124:127], v10 offset:34816
    v_mfma_f32_16x16x32_bf16 v[64:67], v[108:111], v[96:99], v[64:67]
    ds_read_b128 v[132:135], v10 offset:35840
    v_mfma_f32_16x16x32_bf16 v[84:87], v[108:111], v[100:103], v[84:87]
    ds_read_b128 v[136:139], v10 offset:36864
    s_waitcnt lgkmcnt(9)
    v_mfma_f32_16x16x32_bf16 v[28:31], v[112:115], v[144:147], v[28:31]
    ds_read_b128 v[160:163], v10 offset:37888
    v_mfma_f32_16x16x32_bf16 v[48:51], v[112:115], v[12:15], v[48:51]
    v_mfma_f32_16x16x32_bf16 v[68:71], v[112:115], v[96:99], v[68:71]
    v_mfma_f32_16x16x32_bf16 v[88:91], v[112:115], v[100:103], v[88:91]
    s_waitcnt lgkmcnt(9)
    v_mfma_f32_16x16x32_bf16 v[32:35], v[120:123], v[144:147], v[32:35]
    v_mfma_f32_16x16x32_bf16 v[52:55], v[120:123], v[12:15], v[52:55]
    s_add_u32 m0, s71, 4096
    s_add_u32 s72, s64, 40960
    buffer_load_dwordx4 v6, s[48:51], s72 offen offset:0 sc1 lds
    v_mfma_f32_16x16x32_bf16 v[72:75], v[120:123], v[96:99], v[72:75]
    v_mfma_f32_16x16x32_bf16 v[92:95], v[120:123], v[100:103], v[92:95]
    buffer_load_dwordx4 v6, s[48:51], s72 offen offset:1024 sc1 lds
    s_waitcnt lgkmcnt(4)
    v_mfma_f32_16x16x32_bf16 v[16:19], v[116:119], v[104:107], v[16:19]
    buffer_load_dwordx4 v6, s[48:51], s72 offen offset:2048 sc1 lds
    v_mfma_f32_16x16x32_bf16 v[36:39], v[116:119], v[128:131], v[36:39]
    buffer_load_dwordx4 v6, s[48:51], s72 offen offset:3072 sc1 lds
    v_mfma_f32_16x16x32_bf16 v[56:59], v[116:119], v[148:151], v[56:59]
    s_add_u32 m0, s71, 8192
    s_add_u32 s72, s64, 45056
    buffer_load_dwordx4 v6, s[48:51], s72 offen offset:0 sc1 lds
    v_mfma_f32_16x16x32_bf16 v[76:79], v[116:119], v[152:155], v[76:79]
    s_add_u32 m0, s71, 9216
    s_add_u32 s72, s63, 32768
    buffer_load_dwordx4 v6, s[48:51], s72 offen offset:0 sc1 lds
    s_waitcnt lgkmcnt(3)
    v_mfma_f32_16x16x32_bf16 v[20:23], v[124:127], v[104:107], v[20:23]
    s_waitcnt vmcnt(16)
    ds_read_b128 v[140:143], v10 offset:13312
    v_mfma_f32_16x16x32_bf16 v[40:43], v[124:127], v[128:131], v[40:43]
    ds_read_b128 v[156:159], v2 offset:0
    buffer_load_dwordx4 v6, s[48:51], s72 offen offset:1024 sc1 lds
    v_mfma_f32_16x16x32_bf16 v[60:63], v[124:127], v[148:151], v[60:63]
    ds_read_b128 v[164:167], v3 offset:0
    v_mfma_f32_16x16x32_bf16 v[80:83], v[124:127], v[152:155], v[80:83]
    ds_read_b128 v[108:111], v4 offset:0
    buffer_load_dwordx4 v6, s[48:51], s72 offen offset:2048 sc1 lds
    s_waitcnt lgkmcnt(6)
    v_mfma_f32_16x16x32_bf16 v[24:27], v[132:135], v[104:107], v[24:27]
    ds_read_b128 v[112:115], v5 offset:0
    v_mfma_f32_16x16x32_bf16 v[44:47], v[132:135], v[128:131], v[44:47]
    ds_read_b128 v[144:147], v10 offset:14336
    buffer_load_dwordx4 v6, s[48:51], s72 offen offset:3072 sc1 lds
    v_mfma_f32_16x16x32_bf16 v[64:67], v[132:135], v[148:151], v[64:67]
    ds_read_b128 v[12:15], v10 offset:15360
    v_mfma_f32_16x16x32_bf16 v[84:87], v[132:135], v[152:155], v[84:87]
    ds_read_b128 v[96:99], v10 offset:16384
    s_waitcnt lgkmcnt(9)
    v_mfma_f32_16x16x32_bf16 v[28:31], v[136:139], v[104:107], v[28:31]
    ds_read_b128 v[120:123], v10 offset:17408
    v_mfma_f32_16x16x32_bf16 v[48:51], v[136:139], v[128:131], v[48:51]
    v_mfma_f32_16x16x32_bf16 v[68:71], v[136:139], v[148:151], v[68:71]
    v_mfma_f32_16x16x32_bf16 v[88:91], v[136:139], v[152:155], v[88:91]
    s_waitcnt lgkmcnt(9)
    v_mfma_f32_16x16x32_bf16 v[32:35], v[160:163], v[104:107], v[32:35]
    v_mfma_f32_16x16x32_bf16 v[52:55], v[160:163], v[128:131], v[52:55]
    s_add_u32 m0, s71, 29696
    s_add_u32 s72, s67, 0
    buffer_load_dwordx4 v6, s[48:51], s72 offen offset:0 sc1 lds
    v_mfma_f32_16x16x32_bf16 v[72:75], v[160:163], v[148:151], v[72:75]
    v_mfma_f32_16x16x32_bf16 v[92:95], v[160:163], v[152:155], v[92:95]
    buffer_load_dwordx4 v6, s[48:51], s72 offen offset:1024 sc1 lds
    s_waitcnt lgkmcnt(4)
    v_mfma_f32_16x16x32_bf16 v[16:19], v[140:143], v[156:159], v[16:19]
    buffer_load_dwordx4 v6, s[48:51], s72 offen offset:2048 sc1 lds
    v_mfma_f32_16x16x32_bf16 v[36:39], v[140:143], v[164:167], v[36:39]
    buffer_load_dwordx4 v6, s[48:51], s72 offen offset:3072 sc1 lds
    v_mfma_f32_16x16x32_bf16 v[56:59], v[140:143], v[108:111], v[56:59]
    s_add_u32 m0, s71, 33792
    s_add_u32 s72, s67, 4096
    buffer_load_dwordx4 v6, s[48:51], s72 offen offset:0 sc1 lds
    v_mfma_f32_16x16x32_bf16 v[76:79], v[140:143], v[112:115], v[76:79]
    s_add_u32 m0, s71, 0
    s_add_u32 s72, s66, 4096
    buffer_load_dwordx4 v6, s[48:51], s72 offen offset:0 sc1 lds
    s_waitcnt lgkmcnt(3)
    v_mfma_f32_16x16x32_bf16 v[20:23], v[144:147], v[156:159], v[20:23]
    s_waitcnt vmcnt(15)
    ds_read_b128 v[132:135], v10 offset:25600
    v_mfma_f32_16x16x32_bf16 v[40:43], v[144:147], v[164:167], v[40:43]
    ds_read_b128 v[136:139], v10 offset:26624
    buffer_load_dwordx4 v6, s[48:51], s72 offen offset:1024 sc1 lds
    v_mfma_f32_16x16x32_bf16 v[60:63], v[144:147], v[108:111], v[60:63]
    ds_read_b128 v[128:131], v7 offset:18432
    v_mfma_f32_16x16x32_bf16 v[80:83], v[144:147], v[112:115], v[80:83]
    ds_read_b128 v[148:151], v7 offset:20480
    buffer_load_dwordx4 v6, s[48:51], s72 offen offset:2048 sc1 lds
    s_waitcnt lgkmcnt(6)
    v_mfma_f32_16x16x32_bf16 v[24:27], v[12:15], v[156:159], v[24:27]
    ds_read_b128 v[160:163], v8 offset:18432
    v_mfma_f32_16x16x32_bf16 v[44:47], v[12:15], v[164:167], v[44:47]
    ds_read_b128 v[152:155], v8 offset:20480
    buffer_load_dwordx4 v6, s[48:51], s72 offen offset:3072 sc1 lds
    v_mfma_f32_16x16x32_bf16 v[64:67], v[12:15], v[108:111], v[64:67]
    v_mfma_f32_16x16x32_bf16 v[84:87], v[12:15], v[112:115], v[84:87]
    s_add_u32 m0, s71, 34816
    s_add_u32 s72, s65, 6144
    buffer_load_dwordx4 v6, s[48:51], s72 offen offset:0 sc1 lds
    s_waitcnt lgkmcnt(7)
    v_mfma_f32_16x16x32_bf16 v[28:31], v[96:99], v[156:159], v[28:31]
    v_mfma_f32_16x16x32_bf16 v[48:51], v[96:99], v[164:167], v[48:51]
    buffer_load_dwordx4 v6, s[48:51], s72 offen offset:1024 sc1 lds
    v_mfma_f32_16x16x32_bf16 v[68:71], v[96:99], v[108:111], v[68:71]
    v_mfma_f32_16x16x32_bf16 v[88:91], v[96:99], v[112:115], v[88:91]
    buffer_load_dwordx4 v6, s[48:51], s72 offen offset:2048 sc1 lds
    s_waitcnt lgkmcnt(6)
    v_mfma_f32_16x16x32_bf16 v[32:35], v[120:123], v[156:159], v[32:35]
    v_mfma_f32_16x16x32_bf16 v[52:55], v[120:123], v[164:167], v[52:55]
    buffer_load_dwordx4 v6, s[48:51], s72 offen offset:3072 sc1 lds
    v_mfma_f32_16x16x32_bf16 v[72:75], v[120:123], v[108:111], v[72:75]
    v_mfma_f32_16x16x32_bf16 v[92:95], v[120:123], v[112:115], v[92:95]
    s_add_u32 m0, s71, 13312
    s_add_u32 s72, s64, 46080
    buffer_load_dwordx4 v6, s[48:51], s72 offen offset:0 sc1 lds
    s_waitcnt lgkmcnt(0)
    v_max_u32 v1, v132, v136
    v_cmp_eq_u32 vcc, -1, v1
    s_cbranch_vccnz P6_KS_5
P6_KO_6:
    v_mfma_f32_32x32x16_bf16 v[96:111], v[132:135], v[128:131], 0
    s_waitcnt vmcnt(14)
    ds_read_b128 v[140:143], v10 offset:4096
    buffer_load_dwordx4 v6, s[48:51], s72 offen offset:1024 sc1 lds
    ds_read_b128 v[144:147], v2 offset:9216
    v_mfma_f32_32x32x16_bf16 v[96:111], v[136:139], v[148:151], v[96:111]
    ds_read_b128 v[12:15], v3 offset:9216
    buffer_load_dwordx4 v6, s[48:51], s72 offen offset:2048 sc1 lds
    ds_read_b128 v[156:159], v4 offset:9216
    v_mfma_f32_32x32x16_bf16 v[112:127], v[132:135], v[160:163], 0
    ds_read_b128 v[164:167], v5 offset:9216
    ds_read_b128 v[128:131], v10 offset:5120
    v_mfma_f32_32x32x16_bf16 v[112:127], v[136:139], v[152:155], v[112:127]
    buffer_load_dwordx4 v6, s[48:51], s72 offen offset:3072 sc1 lds
    s_waitcnt lgkmcnt(1)
    v_mfma_f32_16x16x32_bf16 v[16:19], v[140:143], v[144:147], v[16:19]
    s_add_u32 m0, s71, 17408
    s_add_u32 s72, s64, 50176
    buffer_load_dwordx4 v6, s[48:51], s72 offen offset:0 sc1 lds
    v_mfma_f32_16x16x32_bf16 v[36:39], v[140:143], v[12:15], v[36:39]
    s_add_u32 m0, s71, 9216
    s_add_u32 s72, s63, 36864
    buffer_load_dwordx4 v6, s[48:51], s72 offen offset:0 sc1 lds
    v_mfma_f32_16x16x32_bf16 v[56:59], v[140:143], v[156:159], v[56:59]
    buffer_load_dwordx4 v6, s[48:51], s72 offen offset:1024 sc1 lds
    v_mfma_f32_16x16x32_bf16 v[76:79], v[140:143], v[164:167], v[76:79]
    buffer_load_dwordx4 v6, s[48:51], s72 offen offset:2048 sc1 lds
    s_waitcnt lgkmcnt(0)
    v_mfma_f32_16x16x32_bf16 v[20:23], v[128:131], v[144:147], v[20:23]
    s_waitcnt vmcnt(30)
    v_add_f32 v106, 0x358637bd, v106
    v_rcp_f32 v106, v106
    v_mfma_f32_16x16x32_bf16 v[40:43], v[128:131], v[12:15], v[40:43]
    v_add_f32 v122, 0x358637bd, v122
    v_rcp_f32 v122, v122
    buffer_load_dwordx4 v6, s[48:51], s72 offen offset:3072 sc1 lds
    v_mfma_f32_16x16x32_bf16 v[60:63], v[128:131], v[156:159], v[60:63]
    v_pk_mul_f32 v[96:97], v[96:97], v[106:107] op_sel_hi:[1,0]
    v_pk_mul_f32 v[98:99], v[98:99], v[106:107] op_sel_hi:[1,0]
    v_mfma_f32_16x16x32_bf16 v[80:83], v[128:131], v[164:167], v[80:83]
    v_pk_mul_f32 v[100:101], v[100:101], v[106:107] op_sel_hi:[1,0]
    v_pk_mul_f32 v[102:103], v[102:103], v[106:107] op_sel_hi:[1,0]
    ds_read_b128 v[136:139], v10 offset:6144
    s_waitcnt lgkmcnt(0)
    v_mfma_f32_16x16x32_bf16 v[24:27], v[136:139], v[144:147], v[24:27]
    v_pk_mul_f32 v[104:105], v[104:105], v[106:107] op_sel_hi:[1,0]
    v_cvt_pk_bf16_f32 v148, v96, v97
    v_mfma_f32_16x16x32_bf16 v[44:47], v[136:139], v[12:15], v[44:47]
    v_cvt_pk_bf16_f32 v149, v98, v99
    v_cvt_pk_bf16_f32 v150, v100, v101
    v_mfma_f32_16x16x32_bf16 v[64:67], v[136:139], v[156:159], v[64:67]
    v_cvt_pk_bf16_f32 v151, v102, v103
    v_cvt_pk_bf16_f32 v160, v104, v105
    v_mfma_f32_16x16x32_bf16 v[84:87], v[136:139], v[164:167], v[84:87]
    v_pk_mul_f32 v[112:113], v[112:113], v[122:123] op_sel_hi:[1,0]
    v_pk_mul_f32 v[114:115], v[114:115], v[122:123] op_sel_hi:[1,0]
    ds_read_b128 v[140:143], v10 offset:7168
    s_waitcnt lgkmcnt(0)
    v_mfma_f32_16x16x32_bf16 v[28:31], v[140:143], v[144:147], v[28:31]
    v_pk_mul_f32 v[116:117], v[116:117], v[122:123] op_sel_hi:[1,0]
    v_pk_mul_f32 v[118:119], v[118:119], v[122:123] op_sel_hi:[1,0]
    v_mfma_f32_16x16x32_bf16 v[48:51], v[140:143], v[12:15], v[48:51]
    v_pk_mul_f32 v[120:121], v[120:121], v[122:123] op_sel_hi:[1,0]
    v_cvt_pk_bf16_f32 v132, v112, v113
    v_mfma_f32_16x16x32_bf16 v[68:71], v[140:143], v[156:159], v[68:71]
    v_cvt_pk_bf16_f32 v133, v114, v115
    v_cvt_pk_bf16_f32 v134, v116, v117
    v_mfma_f32_16x16x32_bf16 v[88:91], v[140:143], v[164:167], v[88:91]
    v_cvt_pk_bf16_f32 v135, v118, v119
    v_cvt_pk_bf16_f32 v152, v120, v121
    ds_read_b128 v[128:131], v10 offset:8192
    s_waitcnt lgkmcnt(0)
    v_mfma_f32_16x16x32_bf16 v[32:35], v[128:131], v[144:147], v[32:35]
    ds_read_b128 v[136:139], v10 offset:27648
    v_mfma_f32_16x16x32_bf16 v[52:55], v[128:131], v[12:15], v[52:55]
    ds_read_b128 v[140:143], v10 offset:28672
    s_add_u32 m0, s71, 4096
    s_add_u32 s72, s67, 5120
    buffer_load_dwordx4 v6, s[48:51], s72 offen offset:0 sc1 lds
    v_mfma_f32_16x16x32_bf16 v[72:75], v[128:131], v[156:159], v[72:75]
    ds_read_b128 v[144:147], v7 offset:20480
    v_mfma_f32_16x16x32_bf16 v[92:95], v[128:131], v[164:167], v[92:95]
    ds_read_b128 v[12:15], v7 offset:22528
    buffer_load_dwordx4 v6, s[48:51], s72 offen offset:1024 sc1 lds
    ds_read_b128 v[156:159], v8 offset:20480
    ds_read_b128 v[128:131], v8 offset:22528
    s_waitcnt lgkmcnt(0)
    v_max_u32 v1, v136, v140
    v_cmp_eq_u32 vcc, -1, v1
    s_cbranch_vccnz P6_KS_7
P6_KO_8:
    v_mfma_f32_32x32x16_bf16 v[96:111], v[136:139], v[144:147], 0
    s_waitcnt vmcnt(19)
    buffer_load_dwordx4 v6, s[48:51], s72 offen offset:2048 sc1 lds
    v_mfma_f32_32x32x16_bf16 v[96:111], v[140:143], v[12:15], v[96:111]
    ds_read_b128 v[164:167], v10 offset:29696
    buffer_load_dwordx4 v6, s[48:51], s72 offen offset:3072 sc1 lds
    v_mfma_f32_32x32x16_bf16 v[112:127], v[136:139], v[156:159], 0
    ds_read_b128 v[144:147], v10 offset:30720
    ds_read_b128 v[12:15], v10 offset:31744
    v_mfma_f32_32x32x16_bf16 v[112:127], v[140:143], v[128:131], v[112:127]
    s_add_u32 m0, s71, 8192
    s_add_u32 s72, s67, 9216
    buffer_load_dwordx4 v6, s[48:51], s72 offen offset:0 sc1 lds
    s_add_u32 m0, s71, 24576
    s_add_u32 s72, s66, 8192
    buffer_load_dwordx4 v6, s[48:51], s72 offen offset:0 sc1 lds
    buffer_load_dwordx4 v6, s[48:51], s72 offen offset:1024 sc1 lds
    buffer_load_dwordx4 v6, s[48:51], s72 offen offset:2048 sc1 lds
    v_add_f32 v106, 0x358637bd, v106
    v_rcp_f32 v106, v106
    s_nop 1
    v_add_f32 v122, 0x358637bd, v122
    v_rcp_f32 v122, v122
    v_pk_mul_f32 v[96:97], v[96:97], v[106:107] op_sel_hi:[1,0]
    v_pk_mul_f32 v[98:99], v[98:99], v[106:107] op_sel_hi:[1,0]
    v_pk_mul_f32 v[100:101], v[100:101], v[106:107] op_sel_hi:[1,0]
    v_pk_mul_f32 v[102:103], v[102:103], v[106:107] op_sel_hi:[1,0]
    v_pk_mul_f32 v[104:105], v[104:105], v[106:107] op_sel_hi:[1,0]
    v_cvt_pk_bf16_f32 v161, v96, v97
    v_cvt_pk_bf16_f32 v162, v98, v99
    v_cvt_pk_bf16_f32 v163, v100, v101
    v_cvt_pk_bf16_f32 v156, v102, v103
    v_cvt_pk_bf16_f32 v157, v104, v105
    v_pk_mul_f32 v[112:113], v[112:113], v[122:123] op_sel_hi:[1,0]
    v_pk_mul_f32 v[114:115], v[114:115], v[122:123] op_sel_hi:[1,0]
    v_pk_mul_f32 v[116:117], v[116:117], v[122:123] op_sel_hi:[1,0]
    v_pk_mul_f32 v[118:119], v[118:119], v[122:123] op_sel_hi:[1,0]
    v_pk_mul_f32 v[120:121], v[120:121], v[122:123] op_sel_hi:[1,0]
    v_cvt_pk_bf16_f32 v153, v112, v113
    v_cvt_pk_bf16_f32 v154, v114, v115
    v_cvt_pk_bf16_f32 v155, v116, v117
    v_cvt_pk_bf16_f32 v136, v118, v119
    v_cvt_pk_bf16_f32 v137, v120, v121
    v_permlane16_swap_b32 v148, v160
    v_permlane16_swap_b32 v149, v161
    v_permlane16_swap_b32 v150, v162
    v_permlane16_swap_b32 v151, v163
    v_permlane16_swap_b32 v132, v152
    v_permlane16_swap_b32 v133, v153
    v_permlane16_swap_b32 v134, v154
    v_permlane16_swap_b32 v135, v155
    s_waitcnt lgkmcnt(2)
    v_mfma_f32_16x16x32_bf16 v[16:19], v[164:167], v[148:151], v[16:19]
    buffer_load_dwordx4 v6, s[48:51], s72 offen offset:3072 sc1 lds
    v_mfma_f32_16x16x32_bf16 v[36:39], v[164:167], v[160:163], v[36:39]
    v_mfma_f32_16x16x32_bf16 v[56:59], v[164:167], v[132:135], v[56:59]
    v_mfma_f32_16x16x32_bf16 v[76:79], v[164:167], v[152:155], v[76:79]
    ds_read_b128 v[128:131], v10 offset:32768
    s_waitcnt lgkmcnt(2)
    v_mfma_f32_16x16x32_bf16 v[20:23], v[144:147], v[148:151], v[20:23]
    s_waitcnt vmcnt(18)
    v_mfma_f32_16x16x32_bf16 v[40:43], v[144:147], v[160:163], v[40:43]
    v_mfma_f32_16x16x32_bf16 v[60:63], v[144:147], v[132:135], v[60:63]
    v_mfma_f32_16x16x32_bf16 v[80:83], v[144:147], v[152:155], v[80:83]
    ds_read_b128 v[140:143], v10 offset:33792
    s_waitcnt lgkmcnt(2)
    v_mfma_f32_16x16x32_bf16 v[24:27], v[12:15], v[148:151], v[24:27]
    v_mfma_f32_16x16x32_bf16 v[44:47], v[12:15], v[160:163], v[44:47]
    v_mfma_f32_16x16x32_bf16 v[64:67], v[12:15], v[132:135], v[64:67]
    v_mfma_f32_16x16x32_bf16 v[84:87], v[12:15], v[152:155], v[84:87]
    ds_read_b128 v[164:167], v10 offset:0
    s_waitcnt lgkmcnt(2)
    v_mfma_f32_16x16x32_bf16 v[28:31], v[128:131], v[148:151], v[28:31]
    v_mfma_f32_16x16x32_bf16 v[48:51], v[128:131], v[160:163], v[48:51]
    v_mfma_f32_16x16x32_bf16 v[68:71], v[128:131], v[132:135], v[68:71]
    v_mfma_f32_16x16x32_bf16 v[88:91], v[128:131], v[152:155], v[88:91]
    ds_read_b128 v[144:147], v10 offset:1024
    s_waitcnt lgkmcnt(2)
    v_mfma_f32_16x16x32_bf16 v[32:35], v[140:143], v[148:151], v[32:35]
    ds_read_b128 v[12:15], v7 offset:22528
    v_mfma_f32_16x16x32_bf16 v[52:55], v[140:143], v[160:163], v[52:55]
    ds_read_b128 v[128:131], v7 offset:34816
    s_add_u32 m0, s71, 28672
    s_add_u32 s72, s65, 10240
    buffer_load_dwordx4 v6, s[48:51], s72 offen offset:0 sc1 lds
    v_mfma_f32_16x16x32_bf16 v[72:75], v[140:143], v[132:135], v[72:75]
    ds_read_b128 v[148:151], v8 offset:22528
    v_mfma_f32_16x16x32_bf16 v[92:95], v[140:143], v[152:155], v[92:95]
    ds_read_b128 v[160:163], v8 offset:34816
    buffer_load_dwordx4 v6, s[48:51], s72 offen offset:1024 sc1 lds
    s_waitcnt lgkmcnt(0)
    v_max_u32 v1, v164, v144
    v_cmp_eq_u32 vcc, -1, v1
    s_cbranch_vccnz P6_KS_9
P6_KO_10:
    v_mfma_f32_32x32x16_bf16 v[96:111], v[164:167], v[12:15], 0
    s_waitcnt vmcnt(11)
    ds_read_b128 v[132:135], v10 offset:13312
    buffer_load_dwordx4 v6, s[48:51], s72 offen offset:2048 sc1 lds
    ds_read_b128 v[140:143], v2 offset:9216
    v_mfma_f32_32x32x16_bf16 v[96:111], v[144:147], v[128:131], v[96:111]
    ds_read_b128 v[152:155], v3 offset:9216
    buffer_load_dwordx4 v6, s[48:51], s72 offen offset:3072 sc1 lds
    v_mfma_f32_32x32x16_bf16 v[112:127], v[164:167], v[148:151], 0
    ds_read_b128 v[12:15], v4 offset:9216
    ds_read_b128 v[128:131], v5 offset:9216
    v_mfma_f32_32x32x16_bf16 v[112:127], v[144:147], v[160:163], v[112:127]
    s_add_u32 m0, s71, 32768
    s_add_u32 s72, s65, 14336
    buffer_load_dwordx4 v6, s[48:51], s72 offen offset:0 sc1 lds
    s_waitcnt lgkmcnt(0)
    v_mfma_f32_16x16x32_bf16 v[16:19], v[132:135], v[140:143], v[16:19]
    buffer_load_dwordx4 v6, s[48:51], s72 offen offset:1024 sc1 lds
    v_mfma_f32_16x16x32_bf16 v[36:39], v[132:135], v[152:155], v[36:39]
    s_add_u32 m0, s71, 18432
    s_add_u32 s72, s67, 10240
    buffer_load_dwordx4 v6, s[48:51], s72 offen offset:0 sc1 lds
    v_mfma_f32_16x16x32_bf16 v[56:59], v[132:135], v[12:15], v[56:59]
    buffer_load_dwordx4 v6, s[48:51], s72 offen offset:1024 sc1 lds
    v_mfma_f32_16x16x32_bf16 v[76:79], v[132:135], v[128:131], v[76:79]
    ds_read_b128 v[160:163], v10 offset:14336
    buffer_load_dwordx4 v6, s[48:51], s72 offen offset:2048 sc1 lds
    s_waitcnt lgkmcnt(0)
    v_mfma_f32_16x16x32_bf16 v[20:23], v[160:163], v[140:143], v[20:23]
    s_waitcnt vmcnt(27)
    v_add_f32 v106, 0x358637bd, v106
    v_rcp_f32 v106, v106
    v_mfma_f32_16x16x32_bf16 v[40:43], v[160:163], v[152:155], v[40:43]
    v_add_f32 v122, 0x358637bd, v122
    v_rcp_f32 v122, v122
    buffer_load_dwordx4 v6, s[48:51], s72 offen offset:3072 sc1 lds
    v_mfma_f32_16x16x32_bf16 v[60:63], v[160:163], v[12:15], v[60:63]
    v_pk_mul_f32 v[96:97], v[96:97], v[106:107] op_sel_hi:[1,0]
    v_pk_mul_f32 v[98:99], v[98:99], v[106:107] op_sel_hi:[1,0]
    v_mfma_f32_16x16x32_bf16 v[80:83], v[160:163], v[128:131], v[80:83]
    v_pk_mul_f32 v[100:101], v[100:101], v[106:107] op_sel_hi:[1,0]
    v_pk_mul_f32 v[102:103], v[102:103], v[106:107] op_sel_hi:[1,0]
    ds_read_b128 v[144:147], v10 offset:15360
    s_add_u32 m0, s71, 22528
    s_add_u32 s72, s67, 14336
    buffer_load_dwordx4 v6, s[48:51], s72 offen offset:0 sc1 lds
    s_waitcnt lgkmcnt(0)
    v_mfma_f32_16x16x32_bf16 v[24:27], v[144:147], v[140:143], v[24:27]
    v_pk_mul_f32 v[104:105], v[104:105], v[106:107] op_sel_hi:[1,0]
    v_cvt_pk_bf16_f32 v158, v96, v97
    v_mfma_f32_16x16x32_bf16 v[44:47], v[144:147], v[152:155], v[44:47]
    v_cvt_pk_bf16_f32 v159, v98, v99
    v_cvt_pk_bf16_f32 v148, v100, v101
    v_mfma_f32_16x16x32_bf16 v[64:67], v[144:147], v[12:15], v[64:67]
    v_cvt_pk_bf16_f32 v149, v102, v103
    v_cvt_pk_bf16_f32 v150, v104, v105
    v_mfma_f32_16x16x32_bf16 v[84:87], v[144:147], v[128:131], v[84:87]
    v_pk_mul_f32 v[112:113], v[112:113], v[122:123] op_sel_hi:[1,0]
    v_pk_mul_f32 v[114:115], v[114:115], v[122:123] op_sel_hi:[1,0]
    ds_read_b128 v[132:135], v10 offset:16384
    s_waitcnt lgkmcnt(0)
    v_mfma_f32_16x16x32_bf16 v[28:31], v[132:135], v[140:143], v[28:31]
    v_pk_mul_f32 v[116:117], v[116:117], v[122:123] op_sel_hi:[1,0]
    v_pk_mul_f32 v[118:119], v[118:119], v[122:123] op_sel_hi:[1,0]
    v_mfma_f32_16x16x32_bf16 v[48:51], v[132:135], v[152:155], v[48:51]
    v_pk_mul_f32 v[120:121], v[120:121], v[122:123] op_sel_hi:[1,0]
    v_cvt_pk_bf16_f32 v138, v112, v113
    v_mfma_f32_16x16x32_bf16 v[68:71], v[132:135], v[12:15], v[68:71]
    v_cvt_pk_bf16_f32 v139, v114, v115
    v_cvt_pk_bf16_f32 v164, v116, v117
    v_mfma_f32_16x16x32_bf16 v[88:91], v[132:135], v[128:131], v[88:91]
    v_cvt_pk_bf16_f32 v165, v118, v119
    v_cvt_pk_bf16_f32 v166, v120, v121
    ds_read_b128 v[160:163], v10 offset:17408
    s_waitcnt lgkmcnt(0)
    v_mfma_f32_16x16x32_bf16 v[32:35], v[160:163], v[140:143], v[32:35]
    ds_read_b128 v[144:147], v10 offset:2048
    v_mfma_f32_16x16x32_bf16 v[52:55], v[160:163], v[152:155], v[52:55]
    ds_read_b128 v[132:135], v10 offset:3072
    s_add_u32 m0, s71, 9216
    s_add_u32 s72, s64, 51200
    buffer_load_dwordx4 v6, s[48:51], s72 offen offset:0 sc1 lds
    v_mfma_f32_16x16x32_bf16 v[72:75], v[160:163], v[12:15], v[72:75]
    ds_read_b128 v[140:143], v7 offset:34816
    v_mfma_f32_16x16x32_bf16 v[92:95], v[160:163], v[128:131], v[92:95]
    ds_read_b128 v[152:155], v7 offset:36864
    buffer_load_dwordx4 v6, s[48:51], s72 offen offset:1024 sc1 lds
    ds_read_b128 v[12:15], v8 offset:34816
    ds_read_b128 v[160:163], v8 offset:36864
    s_waitcnt lgkmcnt(0)
    v_max_u32 v1, v144, v132
    v_cmp_eq_u32 vcc, -1, v1
    s_cbranch_vccnz P6_KS_11
P6_KO_12:
    v_mfma_f32_32x32x16_bf16 v[96:111], v[144:147], v[140:143], 0
    s_waitcnt vmcnt(17)
    buffer_load_dwordx4 v6, s[48:51], s72 offen offset:2048 sc1 lds
    v_mfma_f32_32x32x16_bf16 v[96:111], v[132:135], v[152:155], v[96:111]
    ds_read_b128 v[128:131], v10 offset:4096
    buffer_load_dwordx4 v6, s[48:51], s72 offen offset:3072 sc1 lds
    v_mfma_f32_32x32x16_bf16 v[112:127], v[144:147], v[12:15], 0
    ds_read_b128 v[140:143], v10 offset:5120
    ds_read_b128 v[152:155], v10 offset:6144
    v_mfma_f32_32x32x16_bf16 v[112:127], v[132:135], v[160:163], v[112:127]
    s_add_u32 m0, s71, 13312
    s_add_u32 s72, s64, 55296
    buffer_load_dwordx4 v6, s[48:51], s72 offen offset:0 sc1 lds
    s_add_u32 m0, s71, 0
    s_add_u32 s72, s63, 40960
    buffer_load_dwordx4 v6, s[48:51], s72 offen offset:0 sc1 lds
    buffer_load_dwordx4 v6, s[48:51], s72 offen offset:1024 sc1 lds
    buffer_load_dwordx4 v6, s[48:51], s72 offen offset:2048 sc1 lds
    v_add_f32 v106, 0x358637bd, v106
    v_rcp_f32 v106, v106
    s_nop 1
    v_add_f32 v122, 0x358637bd, v122
    v_rcp_f32 v122, v122
    v_pk_mul_f32 v[96:97], v[96:97], v[106:107] op_sel_hi:[1,0]
    v_pk_mul_f32 v[98:99], v[98:99], v[106:107] op_sel_hi:[1,0]
    v_pk_mul_f32 v[100:101], v[100:101], v[106:107] op_sel_hi:[1,0]
    v_pk_mul_f32 v[102:103], v[102:103], v[106:107] op_sel_hi:[1,0]
    v_pk_mul_f32 v[104:105], v[104:105], v[106:107] op_sel_hi:[1,0]
    v_cvt_pk_bf16_f32 v151, v96, v97
    v_cvt_pk_bf16_f32 v12, v98, v99
    v_cvt_pk_bf16_f32 v13, v100, v101
    v_cvt_pk_bf16_f32 v14, v102, v103
    v_cvt_pk_bf16_f32 v15, v104, v105
    v_pk_mul_f32 v[112:113], v[112:113], v[122:123] op_sel_hi:[1,0]
    v_pk_mul_f32 v[114:115], v[114:115], v[122:123] op_sel_hi:[1,0]
    v_pk_mul_f32 v[116:117], v[116:117], v[122:123] op_sel_hi:[1,0]
    v_pk_mul_f32 v[118:119], v[118:119], v[122:123] op_sel_hi:[1,0]
    v_pk_mul_f32 v[120:121], v[120:121], v[122:123] op_sel_hi:[1,0]
    v_cvt_pk_bf16_f32 v167, v112, v113
    v_cvt_pk_bf16_f32 v144, v114, v115
    v_cvt_pk_bf16_f32 v145, v116, v117
    v_cvt_pk_bf16_f32 v146, v118, v119
    v_cvt_pk_bf16_f32 v147, v120, v121
    v_permlane16_swap_b32 v156, v148
    v_permlane16_swap_b32 v157, v149
    v_permlane16_swap_b32 v158, v150
    v_permlane16_swap_b32 v159, v151
    v_permlane16_swap_b32 v136, v164
    v_permlane16_swap_b32 v137, v165
    v_permlane16_swap_b32 v138, v166
    v_permlane16_swap_b32 v139, v167
    s_waitcnt lgkmcnt(2)
    v_mfma_f32_16x16x32_bf16 v[16:19], v[128:131], v[156:159], v[16:19]
    buffer_load_dwordx4 v6, s[48:51], s72 offen offset:3072 sc1 lds
    v_mfma_f32_16x16x32_bf16 v[36:39], v[128:131], v[148:151], v[36:39]
    s_add_u32 m0, s71, 14336
    s_add_u32 s72, s66, 12288
    buffer_load_dwordx4 v6, s[48:51], s72 offen offset:0 sc1 lds
    v_mfma_f32_16x16x32_bf16 v[56:59], v[128:131], v[136:139], v[56:59]
    buffer_load_dwordx4 v6, s[48:51], s72 offen offset:1024 sc1 lds
    v_mfma_f32_16x16x32_bf16 v[76:79], v[128:131], v[164:167], v[76:79]
    ds_read_b128 v[160:163], v10 offset:7168
    buffer_load_dwordx4 v6, s[48:51], s72 offen offset:2048 sc1 lds
    s_waitcnt lgkmcnt(2)
    v_mfma_f32_16x16x32_bf16 v[20:23], v[140:143], v[156:159], v[20:23]
    s_waitcnt vmcnt(17)
    v_mfma_f32_16x16x32_bf16 v[40:43], v[140:143], v[148:151], v[40:43]
    buffer_load_dwordx4 v6, s[48:51], s72 offen offset:3072 sc1 lds
    v_mfma_f32_16x16x32_bf16 v[60:63], v[140:143], v[136:139], v[60:63]
    v_mfma_f32_16x16x32_bf16 v[80:83], v[140:143], v[164:167], v[80:83]
    ds_read_b128 v[132:135], v10 offset:8192
    s_add_u32 m0, s71, 34816
    s_add_u32 s72, s65, 16384
    buffer_load_dwordx4 v6, s[48:51], s72 offen offset:0 sc1 lds
    s_waitcnt lgkmcnt(2)
    v_mfma_f32_16x16x32_bf16 v[24:27], v[152:155], v[156:159], v[24:27]
    v_mfma_f32_16x16x32_bf16 v[44:47], v[152:155], v[148:151], v[44:47]
    buffer_load_dwordx4 v6, s[48:51], s72 offen offset:1024 sc1 lds
    v_mfma_f32_16x16x32_bf16 v[64:67], v[152:155], v[136:139], v[64:67]
    v_mfma_f32_16x16x32_bf16 v[84:87], v[152:155], v[164:167], v[84:87]
    ds_read_b128 v[128:131], v10 offset:24576
    buffer_load_dwordx4 v6, s[48:51], s72 offen offset:2048 sc1 lds
    s_waitcnt lgkmcnt(2)
    v_mfma_f32_16x16x32_bf16 v[28:31], v[160:163], v[156:159], v[28:31]
    v_mfma_f32_16x16x32_bf16 v[48:51], v[160:163], v[148:151], v[48:51]
    buffer_load_dwordx4 v6, s[48:51], s72 offen offset:3072 sc1 lds
    v_mfma_f32_16x16x32_bf16 v[68:71], v[160:163], v[136:139], v[68:71]
    v_mfma_f32_16x16x32_bf16 v[88:91], v[160:163], v[164:167], v[88:91]
    ds_read_b128 v[140:143], v10 offset:25600
    s_waitcnt lgkmcnt(2)
    v_mfma_f32_16x16x32_bf16 v[32:35], v[132:135], v[156:159], v[32:35]
    ds_read_b128 v[152:155], v7 offset:28672
    v_mfma_f32_16x16x32_bf16 v[52:55], v[132:135], v[148:151], v[52:55]
    ds_read_b128 v[160:163], v7 offset:30720
    s_add_u32 m0, s71, 4096
    s_add_u32 s72, s67, 15360
    buffer_load_dwordx4 v6, s[48:51], s72 offen offset:0 sc1 lds
    v_mfma_f32_16x16x32_bf16 v[72:75], v[132:135], v[136:139], v[72:75]
    ds_read_b128 v[156:159], v8 offset:28672
    v_mfma_f32_16x16x32_bf16 v[92:95], v[132:135], v[164:167], v[92:95]
    ds_read_b128 v[148:151], v8 offset:30720
    buffer_load_dwordx4 v6, s[48:51], s72 offen offset:1024 sc1 lds
    s_waitcnt lgkmcnt(0)
    v_max_u32 v1, v128, v140
    v_cmp_eq_u32 vcc, -1, v1
    s_cbranch_vccnz P6_KS_13
P6_KO_14:
    v_mfma_f32_32x32x16_bf16 v[96:111], v[128:131], v[152:155], 0
    s_waitcnt vmcnt(19)
    ds_read_b128 v[136:139], v10 offset:18432
    buffer_load_dwordx4 v6, s[48:51], s72 offen offset:2048 sc1 lds
    ds_read_b128 v[132:135], v10 offset:19456
    v_mfma_f32_32x32x16_bf16 v[96:111], v[140:143], v[160:163], v[96:111]
    ds_read_b128 v[164:167], v10 offset:20480
    buffer_load_dwordx4 v6, s[48:51], s72 offen offset:3072 sc1 lds
    v_mfma_f32_32x32x16_bf16 v[112:127], v[128:131], v[156:159], 0
    ds_read_b128 v[152:155], v10 offset:21504
    ds_read_b128 v[160:163], v10 offset:22528
    v_mfma_f32_32x32x16_bf16 v[112:127], v[140:143], v[148:151], v[112:127]
    s_add_u32 m0, s71, 8192
    s_add_u32 s72, s67, 19456
    buffer_load_dwordx4 v6, s[48:51], s72 offen offset:0 sc1 lds
    s_nop 2
    v_add_f32 v106, 0x358637bd, v106
    v_rcp_f32 v106, v106
    s_nop 3
    v_add_f32 v122, 0x358637bd, v122
    v_rcp_f32 v122, v122
    v_pk_mul_f32 v[96:97], v[96:97], v[106:107] op_sel_hi:[1,0]
    v_pk_mul_f32 v[98:99], v[98:99], v[106:107] op_sel_hi:[1,0]
    v_pk_mul_f32 v[100:101], v[100:101], v[106:107] op_sel_hi:[1,0]
    v_pk_mul_f32 v[102:103], v[102:103], v[106:107] op_sel_hi:[1,0]
    v_pk_mul_f32 v[104:105], v[104:105], v[106:107] op_sel_hi:[1,0]
    v_cvt_pk_bf16_f32 v156, v96, v97
    v_cvt_pk_bf16_f32 v157, v98, v99
    v_cvt_pk_bf16_f32 v158, v100, v101
    v_cvt_pk_bf16_f32 v159, v102, v103
    v_cvt_pk_bf16_f32 v128, v104, v105
    v_pk_mul_f32 v[112:113], v[112:113], v[122:123] op_sel_hi:[1,0]
    v_pk_mul_f32 v[114:115], v[114:115], v[122:123] op_sel_hi:[1,0]
    v_pk_mul_f32 v[116:117], v[116:117], v[122:123] op_sel_hi:[1,0]
    v_pk_mul_f32 v[118:119], v[118:119], v[122:123] op_sel_hi:[1,0]
    v_pk_mul_f32 v[120:121], v[120:121], v[122:123] op_sel_hi:[1,0]
    v_cvt_pk_bf16_f32 v148, v112, v113
    v_cvt_pk_bf16_f32 v149, v114, v115
    v_cvt_pk_bf16_f32 v150, v116, v117
    v_cvt_pk_bf16_f32 v151, v118, v119
    v_cvt_pk_bf16_f32 v140, v120, v121
    v_permlane16_swap_b32 v12, v156
    v_permlane16_swap_b32 v13, v157
    v_permlane16_swap_b32 v14, v158
    v_permlane16_swap_b32 v15, v159
    v_permlane16_swap_b32 v144, v148
    v_permlane16_swap_b32 v145, v149
    v_permlane16_swap_b32 v146, v150
    v_permlane16_swap_b32 v147, v151
    s_waitcnt lgkmcnt(4)
    v_mfma_f32_16x16x32_bf16 v[16:19], v[136:139], v[12:15], v[16:19]
    v_mfma_f32_16x16x32_bf16 v[36:39], v[136:139], v[156:159], v[36:39]
    v_mfma_f32_16x16x32_bf16 v[56:59], v[136:139], v[144:147], v[56:59]
    v_mfma_f32_16x16x32_bf16 v[76:79], v[136:139], v[148:151], v[76:79]
    s_waitcnt lgkmcnt(3)
    v_mfma_f32_16x16x32_bf16 v[20:23], v[132:135], v[12:15], v[20:23]
    s_waitcnt vmcnt(27)
    v_mfma_f32_16x16x32_bf16 v[40:43], v[132:135], v[156:159], v[40:43]
    v_mfma_f32_16x16x32_bf16 v[60:63], v[132:135], v[144:147], v[60:63]
    v_mfma_f32_16x16x32_bf16 v[80:83], v[132:135], v[148:151], v[80:83]
    s_waitcnt lgkmcnt(2)
    v_mfma_f32_16x16x32_bf16 v[24:27], v[164:167], v[12:15], v[24:27]
    v_mfma_f32_16x16x32_bf16 v[44:47], v[164:167], v[156:159], v[44:47]
    v_mfma_f32_16x16x32_bf16 v[64:67], v[164:167], v[144:147], v[64:67]
    v_mfma_f32_16x16x32_bf16 v[84:87], v[164:167], v[148:151], v[84:87]
    ds_read_b128 v[136:139], v10 offset:26624
    s_waitcnt lgkmcnt(2)
    v_mfma_f32_16x16x32_bf16 v[28:31], v[152:155], v[12:15], v[28:31]
    v_mfma_f32_16x16x32_bf16 v[48:51], v[152:155], v[156:159], v[48:51]
    v_mfma_f32_16x16x32_bf16 v[68:71], v[152:155], v[144:147], v[68:71]
    v_mfma_f32_16x16x32_bf16 v[88:91], v[152:155], v[148:151], v[88:91]
    ds_read_b128 v[132:135], v10 offset:27648
    s_waitcnt lgkmcnt(2)
    v_mfma_f32_16x16x32_bf16 v[32:35], v[160:163], v[12:15], v[32:35]
    ds_read_b128 v[164:167], v7 offset:30720
    v_mfma_f32_16x16x32_bf16 v[52:55], v[160:163], v[156:159], v[52:55]
    ds_read_b128 v[152:155], v7 offset:32768
    s_add_u32 m0, s71, 18432
    s_add_u32 s72, s67, 20480
    buffer_load_dwordx4 v6, s[48:51], s72 offen offset:0 sc1 lds
    v_mfma_f32_16x16x32_bf16 v[72:75], v[160:163], v[144:147], v[72:75]
    ds_read_b128 v[12:15], v8 offset:30720
    v_mfma_f32_16x16x32_bf16 v[92:95], v[160:163], v[148:151], v[92:95]
    ds_read_b128 v[156:159], v8 offset:32768
    buffer_load_dwordx4 v6, s[48:51], s72 offen offset:1024 sc1 lds
    s_waitcnt lgkmcnt(0)
    v_max_u32 v1, v136, v132
    v_cmp_eq_u32 vcc, -1, v1
    s_cbranch_vccnz P6_KS_15
P6_KO_16:
    v_mfma_f32_32x32x16_bf16 v[96:111], v[136:139], v[164:167], 0
    s_waitcnt vmcnt(15)
    ds_read_b128 v[144:147], v10 offset:9216
    buffer_load_dwordx4 v6, s[48:51], s72 offen offset:2048 sc1 lds
    ds_read_b128 v[160:163], v2 offset:0
    v_mfma_f32_32x32x16_bf16 v[96:111], v[132:135], v[152:155], v[96:111]
    ds_read_b128 v[148:151], v3 offset:0
    buffer_load_dwordx4 v6, s[48:51], s72 offen offset:3072 sc1 lds
    v_mfma_f32_32x32x16_bf16 v[112:127], v[136:139], v[12:15], 0
    ds_read_b128 v[164:167], v4 offset:0
    ds_read_b128 v[152:155], v5 offset:0
    v_mfma_f32_32x32x16_bf16 v[112:127], v[132:135], v[156:159], v[112:127]
    s_add_u32 m0, s71, 22528
    s_add_u32 s72, s67, 24576
    buffer_load_dwordx4 v6, s[48:51], s72 offen offset:0 sc1 lds
    s_waitcnt lgkmcnt(0)
    v_mfma_f32_16x16x32_bf16 v[16:19], v[144:147], v[160:163], v[16:19]
    s_add_u32 m0, s71, 23552
    s_add_u32 s72, s64, 56320
    buffer_load_dwordx4 v6, s[48:51], s72 offen offset:0 sc1 lds
    v_mfma_f32_16x16x32_bf16 v[36:39], v[144:147], v[148:151], v[36:39]
    buffer_load_dwordx4 v6, s[48:51], s72 offen offset:1024 sc1 lds
    v_mfma_f32_16x16x32_bf16 v[56:59], v[144:147], v[164:167], v[56:59]
    buffer_load_dwordx4 v6, s[48:51], s72 offen offset:2048 sc1 lds
    v_mfma_f32_16x16x32_bf16 v[76:79], v[144:147], v[152:155], v[76:79]
    ds_read_b128 v[156:159], v10 offset:10240
    buffer_load_dwordx4 v6, s[48:51], s72 offen offset:3072 sc1 lds
    s_waitcnt lgkmcnt(0)
    v_mfma_f32_16x16x32_bf16 v[20:23], v[156:159], v[160:163], v[20:23]
    s_waitcnt vmcnt(14)
    v_add_f32 v106, 0x358637bd, v106
    v_rcp_f32 v106, v106
    v_mfma_f32_16x16x32_bf16 v[40:43], v[156:159], v[148:151], v[40:43]
    v_add_f32 v122, 0x358637bd, v122
    v_rcp_f32 v122, v122
    s_add_u32 m0, s71, 27648
    s_add_u32 s72, s64, 60416
    buffer_load_dwordx4 v6, s[48:51], s72 offen offset:0 sc1 lds
    v_mfma_f32_16x16x32_bf16 v[60:63], v[156:159], v[164:167], v[60:63]
    v_pk_mul_f32 v[96:97], v[96:97], v[106:107] op_sel_hi:[1,0]
    v_pk_mul_f32 v[98:99], v[98:99], v[106:107] op_sel_hi:[1,0]
    v_mfma_f32_16x16x32_bf16 v[80:83], v[156:159], v[152:155], v[80:83]
    v_pk_mul_f32 v[100:101], v[100:101], v[106:107] op_sel_hi:[1,0]
    v_pk_mul_f32 v[102:103], v[102:103], v[106:107] op_sel_hi:[1,0]
    ds_read_b128 v[132:135], v10 offset:11264
    s_add_u32 m0, s71, 0
    s_add_u32 s72, s63, 45056
    buffer_load_dwordx4 v6, s[48:51], s72 offen offset:0 sc1 lds
    s_waitcnt lgkmcnt(0)
    v_mfma_f32_16x16x32_bf16 v[24:27], v[132:135], v[160:163], v[24:27]
    v_pk_mul_f32 v[104:105], v[104:105], v[106:107] op_sel_hi:[1,0]
    v_cvt_pk_bf16_f32 v129, v96, v97
    v_mfma_f32_16x16x32_bf16 v[44:47], v[132:135], v[148:151], v[44:47]
    v_cvt_pk_bf16_f32 v130, v98, v99
    v_cvt_pk_bf16_f32 v131, v100, v101
    buffer_load_dwordx4 v6, s[48:51], s72 offen offset:1024 sc1 lds
    v_mfma_f32_16x16x32_bf16 v[64:67], v[132:135], v[164:167], v[64:67]
    v_cvt_pk_bf16_f32 v12, v102, v103
    v_cvt_pk_bf16_f32 v13, v104, v105
    v_mfma_f32_16x16x32_bf16 v[84:87], v[132:135], v[152:155], v[84:87]
    v_pk_mul_f32 v[112:113], v[112:113], v[122:123] op_sel_hi:[1,0]
    v_pk_mul_f32 v[114:115], v[114:115], v[122:123] op_sel_hi:[1,0]
    ds_read_b128 v[144:147], v10 offset:12288
    buffer_load_dwordx4 v6, s[48:51], s72 offen offset:2048 sc1 lds
    s_waitcnt lgkmcnt(0)
    v_mfma_f32_16x16x32_bf16 v[28:31], v[144:147], v[160:163], v[28:31]
    v_pk_mul_f32 v[116:117], v[116:117], v[122:123] op_sel_hi:[1,0]
    v_pk_mul_f32 v[118:119], v[118:119], v[122:123] op_sel_hi:[1,0]
    v_mfma_f32_16x16x32_bf16 v[48:51], v[144:147], v[148:151], v[48:51]
    v_pk_mul_f32 v[120:121], v[120:121], v[122:123] op_sel_hi:[1,0]
    v_cvt_pk_bf16_f32 v141, v112, v113
    buffer_load_dwordx4 v6, s[48:51], s72 offen offset:3072 sc1 lds
    v_mfma_f32_16x16x32_bf16 v[68:71], v[144:147], v[164:167], v[68:71]
    v_cvt_pk_bf16_f32 v142, v114, v115
    v_cvt_pk_bf16_f32 v143, v116, v117
    v_mfma_f32_16x16x32_bf16 v[88:91], v[144:147], v[152:155], v[88:91]
    v_cvt_pk_bf16_f32 v136, v118, v119
    v_cvt_pk_bf16_f32 v137, v120, v121
    ds_read_b128 v[156:159], v10 offset:13312
    s_waitcnt lgkmcnt(0)
    v_mfma_f32_16x16x32_bf16 v[32:35], v[156:159], v[160:163], v[32:35]
    ds_read_b128 v[132:135], v10 offset:14336
    v_mfma_f32_16x16x32_bf16 v[52:55], v[156:159], v[148:151], v[52:55]
    ds_read_b128 v[144:147], v10 offset:15360
    s_add_u32 m0, s71, 9216
    s_add_u32 s72, s64, 61440
    buffer_load_dwordx4 v6, s[48:51], s72 offen offset:0 sc1 lds
    v_mfma_f32_16x16x32_bf16 v[72:75], v[156:159], v[164:167], v[72:75]
    ds_read_b128 v[160:163], v7 offset:32768
    v_mfma_f32_16x16x32_bf16 v[92:95], v[156:159], v[152:155], v[92:95]
    ds_read_b128 v[148:151], v7 offset:34816
    buffer_load_dwordx4 v6, s[48:51], s72 offen offset:1024 sc1 lds
    ds_read_b128 v[164:167], v8 offset:32768
    ds_read_b128 v[156:159], v8 offset:34816
    s_waitcnt lgkmcnt(0)
    v_max_u32 v1, v132, v144
    v_cmp_eq_u32 vcc, -1, v1
    s_cbranch_vccnz P6_KS_17
P6_KO_18:
    v_mfma_f32_32x32x16_bf16 v[96:111], v[132:135], v[160:163], 0
    s_waitcnt vmcnt(16)
    buffer_load_dwordx4 v6, s[48:51], s72 offen offset:2048 sc1 lds
    v_mfma_f32_32x32x16_bf16 v[96:111], v[144:147], v[148:151], v[96:111]
    ds_read_b128 v[152:155], v10 offset:4096
    buffer_load_dwordx4 v6, s[48:51], s72 offen offset:3072 sc1 lds
    v_mfma_f32_32x32x16_bf16 v[112:127], v[132:135], v[164:167], 0
    ds_read_b128 v[160:163], v10 offset:5120
    ds_read_b128 v[148:151], v10 offset:6144
    v_mfma_f32_32x32x16_bf16 v[112:127], v[144:147], v[156:159], v[112:127]
    s_add_u32 m0, s71, 13312
    s_add_u32 s72, s64, 65536
    buffer_load_dwordx4 v6, s[48:51], s72 offen offset:0 sc1 lds
    s_add_u32 m0, s71, 28672
    s_add_u32 s72, s63, 49152
    buffer_load_dwordx4 v6, s[48:51], s72 offen offset:0 sc1 lds
    buffer_load_dwordx4 v6, s[48:51], s72 offen offset:1024 sc1 lds
    buffer_load_dwordx4 v6, s[48:51], s72 offen offset:2048 sc1 lds
    v_add_f32 v106, 0x358637bd, v106
    v_rcp_f32 v106, v106
    s_nop 1
    v_add_f32 v122, 0x358637bd, v122
    v_rcp_f32 v122, v122
    v_pk_mul_f32 v[96:97], v[96:97], v[106:107] op_sel_hi:[1,0]
    v_pk_mul_f32 v[98:99], v[98:99], v[106:107] op_sel_hi:[1,0]
    v_pk_mul_f32 v[100:101], v[100:101], v[106:107] op_sel_hi:[1,0]
    v_pk_mul_f32 v[102:103], v[102:103], v[106:107] op_sel_hi:[1,0]
    v_pk_mul_f32 v[104:105], v[104:105], v[106:107] op_sel_hi:[1,0]
    v_cvt_pk_bf16_f32 v14, v96, v97
    v_cvt_pk_bf16_f32 v15, v98, v99
    v_cvt_pk_bf16_f32 v164, v100, v101
    v_cvt_pk_bf16_f32 v165, v102, v103
    v_cvt_pk_bf16_f32 v166, v104, v105
    v_pk_mul_f32 v[112:113], v[112:113], v[122:123] op_sel_hi:[1,0]
    v_pk_mul_f32 v[114:115], v[114:115], v[122:123] op_sel_hi:[1,0]
    v_pk_mul_f32 v[116:117], v[116:117], v[122:123] op_sel_hi:[1,0]
    v_pk_mul_f32 v[118:119], v[118:119], v[122:123] op_sel_hi:[1,0]
    v_pk_mul_f32 v[120:121], v[120:121], v[122:123] op_sel_hi:[1,0]
    v_cvt_pk_bf16_f32 v138, v112, v113
    v_cvt_pk_bf16_f32 v139, v114, v115
    v_cvt_pk_bf16_f32 v132, v116, v117
    v_cvt_pk_bf16_f32 v133, v118, v119
    v_cvt_pk_bf16_f32 v134, v120, v121
    v_permlane16_swap_b32 v128, v12
    v_permlane16_swap_b32 v129, v13
    v_permlane16_swap_b32 v130, v14
    v_permlane16_swap_b32 v131, v15
    v_permlane16_swap_b32 v140, v136
    v_permlane16_swap_b32 v141, v137
    v_permlane16_swap_b32 v142, v138
    v_permlane16_swap_b32 v143, v139
    s_waitcnt lgkmcnt(2)
    v_mfma_f32_16x16x32_bf16 v[16:19], v[152:155], v[128:131], v[16:19]
    buffer_load_dwordx4 v6, s[48:51], s72 offen offset:3072 sc1 lds
    v_mfma_f32_16x16x32_bf16 v[36:39], v[152:155], v[12:15], v[36:39]
    v_mfma_f32_16x16x32_bf16 v[56:59], v[152:155], v[140:143], v[56:59]
    v_mfma_f32_16x16x32_bf16 v[76:79], v[152:155], v[136:139], v[76:79]
    ds_read_b128 v[156:159], v10 offset:7168
    s_waitcnt lgkmcnt(2)
    v_mfma_f32_16x16x32_bf16 v[20:23], v[160:163], v[128:131], v[20:23]
    s_waitcnt vmcnt(28)
    v_mfma_f32_16x16x32_bf16 v[40:43], v[160:163], v[12:15], v[40:43]
    v_mfma_f32_16x16x32_bf16 v[60:63], v[160:163], v[140:143], v[60:63]
    v_mfma_f32_16x16x32_bf16 v[80:83], v[160:163], v[136:139], v[80:83]
    ds_read_b128 v[144:147], v10 offset:8192
    s_waitcnt lgkmcnt(2)
    v_mfma_f32_16x16x32_bf16 v[24:27], v[148:151], v[128:131], v[24:27]
    v_mfma_f32_16x16x32_bf16 v[44:47], v[148:151], v[12:15], v[44:47]
    v_mfma_f32_16x16x32_bf16 v[64:67], v[148:151], v[140:143], v[64:67]
    v_mfma_f32_16x16x32_bf16 v[84:87], v[148:151], v[136:139], v[84:87]
    ds_read_b128 v[152:155], v10 offset:16384
    s_waitcnt lgkmcnt(2)
    v_mfma_f32_16x16x32_bf16 v[28:31], v[156:159], v[128:131], v[28:31]
    v_mfma_f32_16x16x32_bf16 v[48:51], v[156:159], v[12:15], v[48:51]
    v_mfma_f32_16x16x32_bf16 v[68:71], v[156:159], v[140:143], v[68:71]
    v_mfma_f32_16x16x32_bf16 v[88:91], v[156:159], v[136:139], v[88:91]
    ds_read_b128 v[160:163], v10 offset:17408
    s_waitcnt lgkmcnt(2)
    v_mfma_f32_16x16x32_bf16 v[32:35], v[144:147], v[128:131], v[32:35]
    ds_read_b128 v[148:151], v7 offset:34816
    v_mfma_f32_16x16x32_bf16 v[52:55], v[144:147], v[12:15], v[52:55]
    ds_read_b128 v[156:159], v7 offset:36864
    s_add_u32 m0, s71, 4096
    s_add_u32 s72, s69, 0
    buffer_load_dwordx4 v6, s[48:51], s72 offen offset:0 sc1 lds
    v_mfma_f32_16x16x32_bf16 v[72:75], v[144:147], v[140:143], v[72:75]
    ds_read_b128 v[128:131], v8 offset:34816
    v_mfma_f32_16x16x32_bf16 v[92:95], v[144:147], v[136:139], v[92:95]
    ds_read_b128 v[12:15], v8 offset:36864
    buffer_load_dwordx4 v6, s[48:51], s72 offen offset:1024 sc1 lds
    s_waitcnt lgkmcnt(0)
    v_max_u32 v1, v152, v160
    v_cmp_eq_u32 vcc, -1, v1
    s_cbranch_vccnz P6_KS_19
P6_KO_20:
    v_mfma_f32_32x32x16_bf16 v[96:111], v[152:155], v[148:151], 0
    s_waitcnt vmcnt(20)
    ds_read_b128 v[140:143], v10 offset:18432
    buffer_load_dwordx4 v6, s[48:51], s72 offen offset:2048 sc1 lds
    ds_read_b128 v[144:147], v10 offset:19456
    v_mfma_f32_32x32x16_bf16 v[96:111], v[160:163], v[156:159], v[96:111]
    ds_read_b128 v[136:139], v10 offset:20480
    buffer_load_dwordx4 v6, s[48:51], s72 offen offset:3072 sc1 lds
    v_mfma_f32_32x32x16_bf16 v[112:127], v[152:155], v[128:131], 0
    ds_read_b128 v[148:151], v10 offset:21504
    ds_read_b128 v[156:159], v10 offset:22528
    v_mfma_f32_32x32x16_bf16 v[112:127], v[160:163], v[12:15], v[112:127]
    s_add_u32 m0, s71, 8192
    s_add_u32 s72, s69, 4096
    buffer_load_dwordx4 v6, s[48:51], s72 offen offset:0 sc1 lds
    s_add_u32 m0, s71, 14336
    s_add_u32 s72, s68, 0
    buffer_load_dwordx4 v6, s[48:51], s72 offen offset:0 sc1 lds
    buffer_load_dwordx4 v6, s[48:51], s72 offen offset:1024 sc1 lds
    buffer_load_dwordx4 v6, s[48:51], s72 offen offset:2048 sc1 lds
    v_add_f32 v106, 0x358637bd, v106
    v_rcp_f32 v106, v106
    s_nop 1
    v_add_f32 v122, 0x358637bd, v122
    v_rcp_f32 v122, v122
    v_pk_mul_f32 v[96:97], v[96:97], v[106:107] op_sel_hi:[1,0]
    v_pk_mul_f32 v[98:99], v[98:99], v[106:107] op_sel_hi:[1,0]
    v_pk_mul_f32 v[100:101], v[100:101], v[106:107] op_sel_hi:[1,0]
    v_pk_mul_f32 v[102:103], v[102:103], v[106:107] op_sel_hi:[1,0]
    v_pk_mul_f32 v[104:105], v[104:105], v[106:107] op_sel_hi:[1,0]
    v_cvt_pk_bf16_f32 v167, v96, v97
    v_cvt_pk_bf16_f32 v128, v98, v99
    v_cvt_pk_bf16_f32 v129, v100, v101
    v_cvt_pk_bf16_f32 v130, v102, v103
    v_cvt_pk_bf16_f32 v131, v104, v105
    v_pk_mul_f32 v[112:113], v[112:113], v[122:123] op_sel_hi:[1,0]
    v_pk_mul_f32 v[114:115], v[114:115], v[122:123] op_sel_hi:[1,0]
    v_pk_mul_f32 v[116:117], v[116:117], v[122:123] op_sel_hi:[1,0]
    v_pk_mul_f32 v[118:119], v[118:119], v[122:123] op_sel_hi:[1,0]
    v_pk_mul_f32 v[120:121], v[120:121], v[122:123] op_sel_hi:[1,0]
    v_cvt_pk_bf16_f32 v135, v112, v113
    v_cvt_pk_bf16_f32 v152, v114, v115
    v_cvt_pk_bf16_f32 v153, v116, v117
    v_cvt_pk_bf16_f32 v154, v118, v119
    v_cvt_pk_bf16_f32 v155, v120, v121
    v_permlane16_swap_b32 v164, v128
    v_permlane16_swap_b32 v165, v129
    v_permlane16_swap_b32 v166, v130
    v_permlane16_swap_b32 v167, v131
    v_permlane16_swap_b32 v132, v152
    v_permlane16_swap_b32 v133, v153
    v_permlane16_swap_b32 v134, v154
    v_permlane16_swap_b32 v135, v155
    s_waitcnt lgkmcnt(4)
    v_mfma_f32_16x16x32_bf16 v[16:19], v[140:143], v[164:167], v[16:19]
    buffer_load_dwordx4 v6, s[48:51], s72 offen offset:3072 sc1 lds
    v_mfma_f32_16x16x32_bf16 v[36:39], v[140:143], v[128:131], v[36:39]
    v_mfma_f32_16x16x32_bf16 v[56:59], v[140:143], v[132:135], v[56:59]
    v_mfma_f32_16x16x32_bf16 v[76:79], v[140:143], v[152:155], v[76:79]
    s_waitcnt lgkmcnt(3)
    v_mfma_f32_16x16x32_bf16 v[20:23], v[144:147], v[164:167], v[20:23]
    s_waitcnt vmcnt(18)
    ds_read_b128 v[12:15], v10 offset:23552
    v_mfma_f32_16x16x32_bf16 v[40:43], v[144:147], v[128:131], v[40:43]
    v_mfma_f32_16x16x32_bf16 v[60:63], v[144:147], v[132:135], v[60:63]
    v_mfma_f32_16x16x32_bf16 v[80:83], v[144:147], v[152:155], v[80:83]
    ds_read_b128 v[160:163], v2 offset:0
    s_waitcnt lgkmcnt(4)
    v_mfma_f32_16x16x32_bf16 v[24:27], v[136:139], v[164:167], v[24:27]
    v_mfma_f32_16x16x32_bf16 v[44:47], v[136:139], v[128:131], v[44:47]
    v_mfma_f32_16x16x32_bf16 v[64:67], v[136:139], v[132:135], v[64:67]
    v_mfma_f32_16x16x32_bf16 v[84:87], v[136:139], v[152:155], v[84:87]
    ds_read_b128 v[140:143], v3 offset:0
    s_waitcnt lgkmcnt(4)
    v_mfma_f32_16x16x32_bf16 v[28:31], v[148:151], v[164:167], v[28:31]
    v_mfma_f32_16x16x32_bf16 v[48:51], v[148:151], v[128:131], v[48:51]
    v_mfma_f32_16x16x32_bf16 v[68:71], v[148:151], v[132:135], v[68:71]
    v_mfma_f32_16x16x32_bf16 v[88:91], v[148:151], v[152:155], v[88:91]
    ds_read_b128 v[144:147], v4 offset:0
    s_waitcnt lgkmcnt(4)
    v_mfma_f32_16x16x32_bf16 v[32:35], v[156:159], v[164:167], v[32:35]
    ds_read_b128 v[136:139], v5 offset:0
    v_mfma_f32_16x16x32_bf16 v[52:55], v[156:159], v[128:131], v[52:55]
    ds_read_b128 v[148:151], v10 offset:24576
    v_mfma_f32_16x16x32_bf16 v[72:75], v[156:159], v[132:135], v[72:75]
    ds_read_b128 v[164:167], v10 offset:25600
    v_mfma_f32_16x16x32_bf16 v[92:95], v[156:159], v[152:155], v[92:95]
    ds_read_b128 v[128:131], v10 offset:26624
    s_waitcnt lgkmcnt(3)
    v_mfma_f32_16x16x32_bf16 v[16:19], v[12:15], v[160:163], v[16:19]
    ds_read_b128 v[100:103], v10 offset:27648
    v_mfma_f32_16x16x32_bf16 v[36:39], v[12:15], v[140:143], v[36:39]
    v_mfma_f32_16x16x32_bf16 v[56:59], v[12:15], v[144:147], v[56:59]
    v_mfma_f32_16x16x32_bf16 v[76:79], v[12:15], v[136:139], v[76:79]
    s_waitcnt lgkmcnt(3)
    v_mfma_f32_16x16x32_bf16 v[20:23], v[148:151], v[160:163], v[20:23]
    s_waitcnt vmcnt(9)
    ds_read_b128 v[116:119], v10 offset:9216
    v_mfma_f32_16x16x32_bf16 v[40:43], v[148:151], v[140:143], v[40:43]
    ds_read_b128 v[124:127], v2 offset:28672
    v_mfma_f32_16x16x32_bf16 v[60:63], v[148:151], v[144:147], v[60:63]
    ds_read_b128 v[104:107], v3 offset:28672
    v_mfma_f32_16x16x32_bf16 v[80:83], v[148:151], v[136:139], v[80:83]
    ds_read_b128 v[96:99], v4 offset:28672
    s_waitcnt lgkmcnt(6)
    v_mfma_f32_16x16x32_bf16 v[24:27], v[164:167], v[160:163], v[24:27]
    ds_read_b128 v[108:111], v5 offset:28672
    v_mfma_f32_16x16x32_bf16 v[44:47], v[164:167], v[140:143], v[44:47]
    ds_read_b128 v[120:123], v10 offset:10240
    v_mfma_f32_16x16x32_bf16 v[64:67], v[164:167], v[144:147], v[64:67]
    ds_read_b128 v[112:115], v10 offset:11264
    v_mfma_f32_16x16x32_bf16 v[84:87], v[164:167], v[136:139], v[84:87]
    ds_read_b128 v[132:135], v10 offset:12288
    s_waitcnt lgkmcnt(9)
    v_mfma_f32_16x16x32_bf16 v[28:31], v[128:131], v[160:163], v[28:31]
    ds_read_b128 v[156:159], v10 offset:13312
    v_mfma_f32_16x16x32_bf16 v[48:51], v[128:131], v[140:143], v[48:51]
    v_mfma_f32_16x16x32_bf16 v[68:71], v[128:131], v[144:147], v[68:71]
    v_mfma_f32_16x16x32_bf16 v[88:91], v[128:131], v[136:139], v[88:91]
    s_waitcnt lgkmcnt(9)
    v_mfma_f32_16x16x32_bf16 v[32:35], v[100:103], v[160:163], v[32:35]
    v_mfma_f32_16x16x32_bf16 v[52:55], v[100:103], v[140:143], v[52:55]
    v_mfma_f32_16x16x32_bf16 v[72:75], v[100:103], v[144:147], v[72:75]
    v_mfma_f32_16x16x32_bf16 v[92:95], v[100:103], v[136:139], v[92:95]
    s_waitcnt lgkmcnt(4)
    v_mfma_f32_16x16x32_bf16 v[16:19], v[116:119], v[124:127], v[16:19]
    v_mfma_f32_16x16x32_bf16 v[36:39], v[116:119], v[104:107], v[36:39]
    v_mfma_f32_16x16x32_bf16 v[56:59], v[116:119], v[96:99], v[56:59]
    v_mfma_f32_16x16x32_bf16 v[76:79], v[116:119], v[108:111], v[76:79]
    s_waitcnt lgkmcnt(3)
    v_mfma_f32_16x16x32_bf16 v[20:23], v[120:123], v[124:127], v[20:23]
    s_waitcnt vmcnt(0)
    ds_read_b128 v[152:155], v10 offset:4096
    v_mfma_f32_16x16x32_bf16 v[40:43], v[120:123], v[104:107], v[40:43]
    ds_read_b128 v[12:15], v2 offset:14336
    v_mfma_f32_16x16x32_bf16 v[60:63], v[120:123], v[96:99], v[60:63]
    ds_read_b128 v[148:151], v3 offset:14336
    v_mfma_f32_16x16x32_bf16 v[80:83], v[120:123], v[108:111], v[80:83]
    ds_read_b128 v[164:167], v10 offset:5120
    s_waitcnt lgkmcnt(6)
    v_mfma_f32_16x16x32_bf16 v[24:27], v[112:115], v[124:127], v[24:27]
    ds_read_b128 v[128:131], v10 offset:6144
    v_mfma_f32_16x16x32_bf16 v[44:47], v[112:115], v[104:107], v[44:47]
    ds_read_b128 v[160:163], v10 offset:7168
    v_mfma_f32_16x16x32_bf16 v[64:67], v[112:115], v[96:99], v[64:67]
    ds_read_b128 v[140:143], v10 offset:8192
    v_mfma_f32_16x16x32_bf16 v[84:87], v[112:115], v[108:111], v[84:87]
    s_waitcnt lgkmcnt(8)
    v_mfma_f32_16x16x32_bf16 v[28:31], v[132:135], v[124:127], v[28:31]
    v_mfma_f32_16x16x32_bf16 v[48:51], v[132:135], v[104:107], v[48:51]
    v_mfma_f32_16x16x32_bf16 v[68:71], v[132:135], v[96:99], v[68:71]
    v_mfma_f32_16x16x32_bf16 v[88:91], v[132:135], v[108:111], v[88:91]
    s_waitcnt lgkmcnt(7)
    v_mfma_f32_16x16x32_bf16 v[32:35], v[156:159], v[124:127], v[32:35]
    v_mfma_f32_16x16x32_bf16 v[52:55], v[156:159], v[104:107], v[52:55]
    v_mfma_f32_16x16x32_bf16 v[72:75], v[156:159], v[96:99], v[72:75]
    v_mfma_f32_16x16x32_bf16 v[92:95], v[156:159], v[108:111], v[92:95]
    s_waitcnt lgkmcnt(4)
    v_mfma_f32_16x16x32_bf16 v[16:19], v[152:155], v[12:15], v[16:19]
    v_mfma_f32_16x16x32_bf16 v[36:39], v[152:155], v[148:151], v[36:39]
    s_waitcnt lgkmcnt(3)
    v_mfma_f32_16x16x32_bf16 v[20:23], v[164:167], v[12:15], v[20:23]
    v_mfma_f32_16x16x32_bf16 v[40:43], v[164:167], v[148:151], v[40:43]
    s_waitcnt lgkmcnt(2)
    v_mfma_f32_16x16x32_bf16 v[24:27], v[128:131], v[12:15], v[24:27]
    v_mfma_f32_16x16x32_bf16 v[44:47], v[128:131], v[148:151], v[44:47]
    s_waitcnt lgkmcnt(1)
    v_mfma_f32_16x16x32_bf16 v[28:31], v[160:163], v[12:15], v[28:31]
    v_mfma_f32_16x16x32_bf16 v[48:51], v[160:163], v[148:151], v[48:51]
    s_waitcnt lgkmcnt(0)
    v_mfma_f32_16x16x32_bf16 v[32:35], v[140:143], v[12:15], v[32:35]
    v_mfma_f32_16x16x32_bf16 v[52:55], v[140:143], v[148:151], v[52:55]
    buffer_load_dwordx2 v[96:97], v9, s[32:35], s70 offen offset:0
    buffer_load_dwordx2 v[98:99], v9, s[32:35], s70 offen offset:32
    buffer_load_dwordx2 v[100:101], v9, s[32:35], s70 offen offset:64
    buffer_load_dwordx2 v[102:103], v9, s[32:35], s70 offen offset:96
    buffer_load_dwordx2 v[104:105], v9, s[32:35], s70 offen offset:128
    s_xor_b32 s72, s60, 1
    s_mul_i32 s72, s72, 39936
    v_add_u32 v2, s72, v6
    s_xor_b32 s72, s60, 2
    s_mul_i32 s72, s72, 39936
    v_add_u32 v3, s72, v6
    s_xor_b32 s72, s60, 3
    s_mul_i32 s72, s72, 39936
    v_add_u32 v4, s72, v6
    ds_write_b128 v10, v[36:39] offset:0
    ds_write_b128 v10, v[56:59] offset:5120
    ds_write_b128 v10, v[76:79] offset:10240
    ds_write_b128 v10, v[40:43] offset:1024
    ds_write_b128 v10, v[60:63] offset:6144
    ds_write_b128 v10, v[80:83] offset:11264
    ds_write_b128 v10, v[44:47] offset:2048
    ds_write_b128 v10, v[64:67] offset:7168
    ds_write_b128 v10, v[84:87] offset:12288
    ds_write_b128 v10, v[48:51] offset:3072
    ds_write_b128 v10, v[68:71] offset:8192
    ds_write_b128 v10, v[88:91] offset:13312
    ds_write_b128 v10, v[52:55] offset:4096
    ds_write_b128 v10, v[72:75] offset:9216
    ds_write_b128 v10, v[92:95] offset:14336
    s_waitcnt lgkmcnt(0)
    s_barrier
    ds_read_b128 v[36:39], v2 offset:0
    ds_read_b128 v[56:59], v3 offset:5120
    ds_read_b128 v[76:79], v4 offset:10240
    ds_read_b128 v[40:43], v2 offset:1024
    ds_read_b128 v[60:63], v3 offset:6144
    ds_read_b128 v[80:83], v4 offset:11264
    ds_read_b128 v[44:47], v2 offset:2048
    ds_read_b128 v[64:67], v3 offset:7168
    ds_read_b128 v[84:87], v4 offset:12288
    ds_read_b128 v[48:51], v2 offset:3072
    ds_read_b128 v[68:71], v3 offset:8192
    ds_read_b128 v[88:91], v4 offset:13312
    ds_read_b128 v[52:55], v2 offset:4096
    ds_read_b128 v[72:75], v3 offset:9216
    ds_read_b128 v[92:95], v4 offset:14336
    s_waitcnt vmcnt(0)
    v_lshlrev_b32 v112, 16, v96
    v_and_b32 v113, 0xffff0000, v96
    v_lshlrev_b32 v114, 16, v97
    v_and_b32 v115, 0xffff0000, v97
    v_pk_add_f32 v[16:17], v[16:17], v[112:113]
    v_pk_add_f32 v[18:19], v[18:19], v[114:115]
    v_lshlrev_b32 v116, 16, v98
    v_and_b32 v117, 0xffff0000, v98
    v_lshlrev_b32 v118, 16, v99
    v_and_b32 v119, 0xffff0000, v99
    v_pk_add_f32 v[20:21], v[20:21], v[116:117]
    v_pk_add_f32 v[22:23], v[22:23], v[118:119]
    v_lshlrev_b32 v120, 16, v100
    v_and_b32 v121, 0xffff0000, v100
    v_lshlrev_b32 v122, 16, v101
    v_and_b32 v123, 0xffff0000, v101
    v_pk_add_f32 v[24:25], v[24:25], v[120:121]
    v_pk_add_f32 v[26:27], v[26:27], v[122:123]
    v_lshlrev_b32 v124, 16, v102
    v_and_b32 v125, 0xffff0000, v102
    v_lshlrev_b32 v126, 16, v103
    v_and_b32 v127, 0xffff0000, v103
    v_pk_add_f32 v[28:29], v[28:29], v[124:125]
    v_pk_add_f32 v[30:31], v[30:31], v[126:127]
    v_lshlrev_b32 v128, 16, v104
    v_and_b32 v129, 0xffff0000, v104
    v_lshlrev_b32 v130, 16, v105
    v_and_b32 v131, 0xffff0000, v105
    v_pk_add_f32 v[32:33], v[32:33], v[128:129]
    v_pk_add_f32 v[34:35], v[34:35], v[130:131]
    s_waitcnt lgkmcnt(12)
    v_pk_add_f32 v[36:37], v[36:37], v[56:57]
    v_pk_add_f32 v[16:17], v[16:17], v[76:77]
    v_pk_add_f32 v[38:39], v[38:39], v[58:59]
    v_pk_add_f32 v[18:19], v[18:19], v[78:79]
    v_pk_add_f32 v[16:17], v[16:17], v[36:37]
    v_pk_add_f32 v[18:19], v[18:19], v[38:39]
    v_cvt_pk_bf16_f32 v96, v16, v17
    v_cvt_pk_bf16_f32 v97, v18, v19
    buffer_store_dwordx2 v[96:97], v9, s[36:39], s70 offen offset:0
    s_waitcnt lgkmcnt(9)
    v_pk_add_f32 v[40:41], v[40:41], v[60:61]
    v_pk_add_f32 v[20:21], v[20:21], v[80:81]
    v_pk_add_f32 v[42:43], v[42:43], v[62:63]
    v_pk_add_f32 v[22:23], v[22:23], v[82:83]
    v_pk_add_f32 v[20:21], v[20:21], v[40:41]
    v_pk_add_f32 v[22:23], v[22:23], v[42:43]
    v_cvt_pk_bf16_f32 v98, v20, v21
    v_cvt_pk_bf16_f32 v99, v22, v23
    buffer_store_dwordx2 v[98:99], v9, s[36:39], s70 offen offset:32
    s_waitcnt lgkmcnt(6)
    v_pk_add_f32 v[44:45], v[44:45], v[64:65]
    v_pk_add_f32 v[24:25], v[24:25], v[84:85]
    v_pk_add_f32 v[46:47], v[46:47], v[66:67]
    v_pk_add_f32 v[26:27], v[26:27], v[86:87]
    v_pk_add_f32 v[24:25], v[24:25], v[44:45]
    v_pk_add_f32 v[26:27], v[26:27], v[46:47]
    v_cvt_pk_bf16_f32 v100, v24, v25
    v_cvt_pk_bf16_f32 v101, v26, v27
    buffer_store_dwordx2 v[100:101], v9, s[36:39], s70 offen offset:64
    s_waitcnt lgkmcnt(3)
    v_pk_add_f32 v[48:49], v[48:49], v[68:69]
    v_pk_add_f32 v[28:29], v[28:29], v[88:89]
    v_pk_add_f32 v[50:51], v[50:51], v[70:71]
    v_pk_add_f32 v[30:31], v[30:31], v[90:91]
    v_pk_add_f32 v[28:29], v[28:29], v[48:49]
    v_pk_add_f32 v[30:31], v[30:31], v[50:51]
    v_cvt_pk_bf16_f32 v102, v28, v29
    v_cvt_pk_bf16_f32 v103, v30, v31
    buffer_store_dwordx2 v[102:103], v9, s[36:39], s70 offen offset:96
    s_waitcnt lgkmcnt(0)
    v_pk_add_f32 v[52:53], v[52:53], v[72:73]
    v_pk_add_f32 v[32:33], v[32:33], v[92:93]
    v_pk_add_f32 v[54:55], v[54:55], v[74:75]
    v_pk_add_f32 v[34:35], v[34:35], v[94:95]
    v_pk_add_f32 v[32:33], v[32:33], v[52:53]
    v_pk_add_f32 v[34:35], v[34:35], v[54:55]
    v_cvt_pk_bf16_f32 v104, v32, v33
    v_cvt_pk_bf16_f32 v105, v34, v35
    buffer_store_dwordx2 v[104:105], v9, s[36:39], s70 offen offset:128
    s_endpgm
P6_KS_5:
    s_mov_b32 s78, 0
P6_KS_5L:
    s_add_u32 s78, s78, 1
    s_cmp_gt_u32 s78, 100000
    s_cbranch_scc1 P6_KO_6
    s_sleep 4
    s_add_u32 s73, s66, 0
    buffer_load_dwordx4 v[132:135], v6, s[48:51], s73 offen sc1
    buffer_load_dwordx4 v[136:139], v6, s[48:51], s73 offen offset:1024 sc1
    s_waitcnt vmcnt(0)
    v_max_u32 v1, v132, v136
    v_cmp_eq_u32 vcc, -1, v1
    s_cbranch_vccnz P6_KS_5L
    s_branch P6_KO_6
P6_KS_7:
    s_mov_b32 s78, 0
P6_KS_7L:
    s_add_u32 s78, s78, 1
    s_cmp_gt_u32 s78, 100000
    s_cbranch_scc1 P6_KO_8
    s_sleep 4
    s_add_u32 s73, s66, 2048
    buffer_load_dwordx4 v[136:139], v6, s[48:51], s73 offen sc1
    buffer_load_dwordx4 v[140:143], v6, s[48:51], s73 offen offset:1024 sc1
    s_waitcnt vmcnt(0)
    v_max_u32 v1, v136, v140
    v_cmp_eq_u32 vcc, -1, v1
    s_cbranch_vccnz P6_KS_7L
    s_branch P6_KO_8
P6_KS_9:
    s_mov_b32 s78, 0
P6_KS_9L:
    s_add_u32 s78, s78, 1
    s_cmp_gt_u32 s78, 100000
    s_cbranch_scc1 P6_KO_10
    s_sleep 4
    s_add_u32 s73, s66, 4096
    buffer_load_dwordx4 v[164:167], v6, s[48:51], s73 offen sc1
    buffer_load_dwordx4 v[144:147], v6, s[48:51], s73 offen offset:1024 sc1
    s_waitcnt vmcnt(0)
    v_max_u32 v1, v164, v144
    v_cmp_eq_u32 vcc, -1, v1
    s_cbranch_vccnz P6_KS_9L
    s_branch P6_KO_10
P6_KS_11:
    s_mov_b32 s78, 0
P6_KS_11L:
    s_add_u32 s78, s78, 1
    s_cmp_gt_u32 s78, 100000
    s_cbranch_scc1 P6_KO_12
    s_sleep 4
    s_add_u32 s73, s66, 6144
    buffer_load_dwordx4 v[144:147], v6, s[48:51], s73 offen sc1
    buffer_load_dwordx4 v[132:135], v6, s[48:51], s73 offen offset:1024 sc1
    s_waitcnt vmcnt(0)
    v_max_u32 v1, v144, v132
    v_cmp_eq_u32 vcc, -1, v1
    s_cbranch_vccnz P6_KS_11L
    s_branch P6_KO_12
P6_KS_13:
    s_mov_b32 s78, 0
P6_KS_13L:
    s_add_u32 s78, s78, 1
    s_cmp_gt_u32 s78, 100000
    s_cbranch_scc1 P6_KO_14
    s_sleep 4
    s_add_u32 s73, s66, 8192
    buffer_load_dwordx4 v[128:131], v6, s[48:51], s73 offen sc1
    buffer_load_dwordx4 v[140:143], v6, s[48:51], s73 offen offset:1024 sc1
    s_waitcnt vmcnt(0)
    v_max_u32 v1, v128, v140
    v_cmp_eq_u32 vcc, -1, v1
    s_cbranch_vccnz P6_KS_13L
    s_branch P6_KO_14
P6_KS_15:
    s_mov_b32 s78, 0
P6_KS_15L:
    s_add_u32 s78, s78, 1
    s_cmp_gt_u32 s78, 100000
    s_cbranch_scc1 P6_KO_16
    s_sleep 4
    s_add_u32 s73, s66, 10240
    buffer_load_dwordx4 v[136:139], v6, s[48:51], s73 offen sc1
    buffer_load_dwordx4 v[132:135], v6, s[48:51], s73 offen offset:1024 sc1
    s_waitcnt vmcnt(0)
    v_max_u32 v1, v136, v132
    v_cmp_eq_u32 vcc, -1, v1
    s_cbranch_vccnz P6_KS_15L
    s_branch P6_KO_16
P6_KS_17:
    s_mov_b32 s78, 0
P6_KS_17L:
    s_add_u32 s78, s78, 1
    s_cmp_gt_u32 s78, 100000
    s_cbranch_scc1 P6_KO_18
    s_sleep 4
    s_add_u32 s73, s66, 12288
    buffer_load_dwordx4 v[132:135], v6, s[48:51], s73 offen sc1
    buffer_load_dwordx4 v[144:147], v6, s[48:51], s73 offen offset:1024 sc1
    s_waitcnt vmcnt(0)
    v_max_u32 v1, v132, v144
    v_cmp_eq_u32 vcc, -1, v1
    s_cbranch_vccnz P6_KS_17L
    s_branch P6_KO_18
P6_KS_19:
    s_mov_b32 s78, 0
P6_KS_19L:
    s_add_u32 s78, s78, 1
    s_cmp_gt_u32 s78, 100000
    s_cbranch_scc1 P6_KO_20
    s_sleep 4
    s_add_u32 s73, s66, 14336
    buffer_load_dwordx4 v[152:155], v6, s[48:51], s73 offen sc1
    buffer_load_dwordx4 v[160:163], v6, s[48:51], s73 offen offset:1024 sc1
    s_waitcnt vmcnt(0)
    v_max_u32 v1, v152, v160
    v_cmp_eq_u32 vcc, -1, v1
    s_cbranch_vccnz P6_KS_19L
    s_branch P6_KO_20
K1_COMP:
    s_and_b32 s60, s24, 3
    s_mov_b32 s83, s26
    s_lshr_b32 s67, s24, 2
    s_cmp_ge_u32 s26, 22
    s_cbranch_scc1 K1_KV
    s_cmp_ge_u32 s26, 18
    s_cbranch_scc1 K1_Q
    v_and_b32 v14, 15, v0
    v_lshrrev_b32 v15, 4, v0
    v_bfe_u32 v9, v0, 1, 3
    v_xor_b32 v9, v9, v15
    s_lshl_b32 s61, s60, 13
    v_lshl_add_u32 v10, v14, 7, s61
    v_lshl_add_u32 v2, v9, 4, v10
    v_xor_b32 v9, 4, v9
    v_lshl_add_u32 v3, v9, 4, v10
    v_bfe_u32 v9, v0, 2, 2
    v_lshl_add_u32 v9, v15, 3, v9
    v_mul_u32_u24 v9, 192, v9
    v_and_b32 v10, 3, v0
    v_lshl_add_u32 v9, v10, 3, v9
    v_bfe_u32 v10, v0, 4, 1
    v_lshlrev_b32 v10, 5, v10
    s_mul_i32 s62, s67, 96
    v_add_u32 v9, s62, v9
    v_add_u32 v11, v9, v10
    v_sub_u32 v12, v9, v10
    s_cmp_eq_u32 s67, 0
    s_cselect_b64 s[68:69], -1, 0
    v_cndmask_b32 v4, v12, v11, s[68:69]
    v_cndmask_b32 v5, v11, v12, s[68:69]
    v_mov_b32 v16, 0
    v_mov_b32 v17, 0
    v_mov_b32 v18, 0
    v_mov_b32 v19, 0
    v_mov_b32 v20, 0
    v_mov_b32 v21, 0
    v_mov_b32 v22, 0
    v_mov_b32 v23, 0
    v_mov_b32 v24, 0
    v_mov_b32 v25, 0
    v_mov_b32 v26, 0
    v_mov_b32 v27, 0
    v_mov_b32 v28, 0
    v_mov_b32 v29, 0
    v_mov_b32 v30, 0
    v_mov_b32 v31, 0
    v_mov_b32 v32, 0
    v_mov_b32 v33, 0
    v_mov_b32 v34, 0
    v_mov_b32 v35, 0
    v_mov_b32 v36, 0
    v_mov_b32 v37, 0
    v_mov_b32 v38, 0
    v_mov_b32 v39, 0
    v_mov_b32 v40, 0
    v_mov_b32 v41, 0
    v_mov_b32 v42, 0
    v_mov_b32 v43, 0
    v_mov_b32 v44, 0
    v_mov_b32 v45, 0
    v_mov_b32 v46, 0
    v_mov_b32 v47, 0
    v_mov_b32 v48, 0
    v_mov_b32 v49, 0
    v_mov_b32 v50, 0
    v_mov_b32 v51, 0
    v_mov_b32 v52, 0
    v_mov_b32 v53, 0
    v_mov_b32 v54, 0
    v_mov_b32 v55, 0
    v_mov_b32 v56, 0
    v_mov_b32 v57, 0
    v_mov_b32 v58, 0
    v_mov_b32 v59, 0
    v_mov_b32 v60, 0
    v_mov_b32 v61, 0
    v_mov_b32 v62, 0
    v_mov_b32 v63, 0
    v_mov_b32 v64, 0
    v_mov_b32 v65, 0
    v_mov_b32 v66, 0
    v_mov_b32 v67, 0
    v_mov_b32 v68, 0
    v_mov_b32 v69, 0
    v_mov_b32 v70, 0
    v_mov_b32 v71, 0
    v_mov_b32 v72, 0
    v_mov_b32 v73, 0
    v_mov_b32 v74, 0
    v_mov_b32 v75, 0
    v_mov_b32 v76, 0
    v_mov_b32 v77, 0
    v_mov_b32 v78, 0
    v_mov_b32 v79, 0
    v_mov_b32 v80, 0
    v_mov_b32 v81, 0
    v_mov_b32 v82, 0
    v_mov_b32 v83, 0
    v_mov_b32 v84, 0
    v_mov_b32 v85, 0
    v_mov_b32 v86, 0
    v_mov_b32 v87, 0
    v_mov_b32 v88, 0
    v_mov_b32 v89, 0
    v_mov_b32 v90, 0
    v_mov_b32 v91, 0
    v_mov_b32 v92, 0
    v_mov_b32 v93, 0
    v_mov_b32 v94, 0
    v_mov_b32 v95, 0
    v_mov_b32 v96, 0
    v_mov_b32 v97, 0
    v_mov_b32 v98, 0
    v_mov_b32 v99, 0
    v_mov_b32 v100, 0
    v_mov_b32 v101, 0
    v_mov_b32 v102, 0
    v_mov_b32 v103, 0
    v_mov_b32 v104, 0
    v_mov_b32 v105, 0
    v_mov_b32 v106, 0
    v_mov_b32 v107, 0
    v_mov_b32 v108, 0
    v_mov_b32 v109, 0
    v_mov_b32 v110, 0
    v_mov_b32 v111, 0
    s_mov_b32 s63, 0
    s_mov_b32 s64, 32768
    s_mov_b32 s65, 98304
    s_mov_b32 s66, 0
    s_cmp_eq_u32 s67, 0
    s_cselect_b32 s71, 8, 99
    v_add_u32 v7, s65, v4
    v_add_u32 v8, s65, v5
    s_barrier
    v_add_u32 v6, s63, v2
    ds_read_b64_tr_b16 v[144:145], v7 offset:0
    ds_read_b64_tr_b16 v[146:147], v7 offset:768
    ds_read_b128 v[112:115], v6 offset:0
    ds_read_b128 v[116:119], v6 offset:2048
    ds_read_b128 v[120:123], v6 offset:4096
    ds_read_b128 v[124:127], v6 offset:6144
    ds_read_b64_tr_b16 v[148:149], v7 offset:6144
    ds_read_b64_tr_b16 v[150:151], v7 offset:6912
    ds_read_b64_tr_b16 v[152:153], v8 offset:32
    ds_read_b64_tr_b16 v[154:155], v8 offset:800
K1_LOOP_F:
    s_waitcnt lgkmcnt(0)
    v_mfma_f32_16x16x32_bf16 v[16:19], v[144:147], v[112:115], v[16:19]
    v_mfma_f32_16x16x32_bf16 v[20:23], v[144:147], v[116:119], v[20:23]
    ds_read_b64_tr_b16 v[156:157], v8 offset:6176
    v_mfma_f32_16x16x32_bf16 v[24:27], v[144:147], v[120:123], v[24:27]
    ds_read_b64_tr_b16 v[158:159], v8 offset:6944
    v_mfma_f32_16x16x32_bf16 v[28:31], v[144:147], v[124:127], v[28:31]
    ds_read_b64_tr_b16 v[160:161], v7 offset:64
    v_mfma_f32_16x16x32_bf16 v[32:35], v[148:151], v[112:115], v[32:35]
    ds_read_b64_tr_b16 v[162:163], v7 offset:832
    v_mfma_f32_16x16x32_bf16 v[36:39], v[148:151], v[116:119], v[36:39]
    ds_read_b64_tr_b16 v[164:165], v7 offset:6208
    v_mfma_f32_16x16x32_bf16 v[40:43], v[148:151], v[120:123], v[40:43]
    ds_read_b64_tr_b16 v[166:167], v7 offset:6976
    v_mfma_f32_16x16x32_bf16 v[44:47], v[148:151], v[124:127], v[44:47]
    v_mfma_f32_16x16x32_bf16 v[48:51], v[152:155], v[112:115], v[48:51]
    v_mfma_f32_16x16x32_bf16 v[52:55], v[152:155], v[116:119], v[52:55]
    v_mfma_f32_16x16x32_bf16 v[56:59], v[152:155], v[120:123], v[56:59]
    v_mfma_f32_16x16x32_bf16 v[60:63], v[152:155], v[124:127], v[60:63]
    s_waitcnt lgkmcnt(0)
    v_mfma_f32_16x16x32_bf16 v[64:67], v[156:159], v[112:115], v[64:67]
    v_mfma_f32_16x16x32_bf16 v[68:71], v[156:159], v[116:119], v[68:71]
    s_barrier
    s_add_u32 s65, s65, 12288
    s_cmp_ge_u32 s65, 159744
    v_mfma_f32_16x16x32_bf16 v[72:75], v[156:159], v[120:123], v[72:75]
    s_cselect_b32 s65, 98304, s65
    v_add_u32 v7, s65, v4
    v_mfma_f32_16x16x32_bf16 v[76:79], v[156:159], v[124:127], v[76:79]
    v_add_u32 v8, s65, v5
    v_add_u32 v6, s63, v3
    v_mfma_f32_16x16x32_bf16 v[80:83], v[160:163], v[112:115], v[80:83]
    ds_read_b64_tr_b16 v[144:145], v7 offset:0
    ds_read_b64_tr_b16 v[146:147], v7 offset:768
    v_mfma_f32_16x16x32_bf16 v[84:87], v[160:163], v[116:119], v[84:87]
    ds_read_b128 v[128:131], v6 offset:0
    ds_read_b128 v[132:135], v6 offset:2048
    v_mfma_f32_16x16x32_bf16 v[88:91], v[160:163], v[120:123], v[88:91]
    ds_read_b128 v[136:139], v6 offset:4096
    ds_read_b128 v[140:143], v6 offset:6144
    v_mfma_f32_16x16x32_bf16 v[92:95], v[160:163], v[124:127], v[92:95]
    ds_read_b64_tr_b16 v[148:149], v7 offset:6144
    v_mfma_f32_16x16x32_bf16 v[96:99], v[164:167], v[112:115], v[96:99]
    ds_read_b64_tr_b16 v[150:151], v7 offset:6912
    v_mfma_f32_16x16x32_bf16 v[100:103], v[164:167], v[116:119], v[100:103]
    ds_read_b64_tr_b16 v[152:153], v8 offset:32
    v_mfma_f32_16x16x32_bf16 v[104:107], v[164:167], v[120:123], v[104:107]
    ds_read_b64_tr_b16 v[154:155], v8 offset:800
    v_mfma_f32_16x16x32_bf16 v[108:111], v[164:167], v[124:127], v[108:111]
    s_waitcnt lgkmcnt(0)
    v_mfma_f32_16x16x32_bf16 v[16:19], v[144:147], v[128:131], v[16:19]
    v_mfma_f32_16x16x32_bf16 v[20:23], v[144:147], v[132:135], v[20:23]
    ds_read_b64_tr_b16 v[156:157], v8 offset:6176
    v_mfma_f32_16x16x32_bf16 v[24:27], v[144:147], v[136:139], v[24:27]
    ds_read_b64_tr_b16 v[158:159], v8 offset:6944
    v_mfma_f32_16x16x32_bf16 v[28:31], v[144:147], v[140:143], v[28:31]
    ds_read_b64_tr_b16 v[160:161], v7 offset:64
    v_mfma_f32_16x16x32_bf16 v[32:35], v[148:151], v[128:131], v[32:35]
    ds_read_b64_tr_b16 v[162:163], v7 offset:832
    v_mfma_f32_16x16x32_bf16 v[36:39], v[148:151], v[132:135], v[36:39]
    ds_read_b64_tr_b16 v[164:165], v7 offset:6208
    v_mfma_f32_16x16x32_bf16 v[40:43], v[148:151], v[136:139], v[40:43]
    ds_read_b64_tr_b16 v[166:167], v7 offset:6976
    v_mfma_f32_16x16x32_bf16 v[44:47], v[148:151], v[140:143], v[44:47]
    v_mfma_f32_16x16x32_bf16 v[48:51], v[152:155], v[128:131], v[48:51]
    v_mfma_f32_16x16x32_bf16 v[52:55], v[152:155], v[132:135], v[52:55]
    v_mfma_f32_16x16x32_bf16 v[56:59], v[152:155], v[136:139], v[56:59]
    v_mfma_f32_16x16x32_bf16 v[60:63], v[152:155], v[140:143], v[60:63]
    s_waitcnt lgkmcnt(0)
    v_mfma_f32_16x16x32_bf16 v[64:67], v[156:159], v[128:131], v[64:67]
    v_mfma_f32_16x16x32_bf16 v[68:71], v[156:159], v[132:135], v[68:71]
    s_barrier
    s_add_u32 s65, s65, 12288
    s_cmp_ge_u32 s65, 159744
    v_mfma_f32_16x16x32_bf16 v[72:75], v[156:159], v[136:139], v[72:75]
    s_cselect_b32 s65, 98304, s65
    v_add_u32 v7, s65, v4
    v_mfma_f32_16x16x32_bf16 v[76:79], v[156:159], v[140:143], v[76:79]
    v_add_u32 v8, s65, v5
    v_add_u32 v6, s64, v2
    v_mfma_f32_16x16x32_bf16 v[80:83], v[160:163], v[128:131], v[80:83]
    ds_read_b64_tr_b16 v[144:145], v7 offset:0
    ds_read_b64_tr_b16 v[146:147], v7 offset:768
    v_mfma_f32_16x16x32_bf16 v[84:87], v[160:163], v[132:135], v[84:87]
    ds_read_b128 v[112:115], v6 offset:0
    ds_read_b128 v[116:119], v6 offset:2048
    v_mfma_f32_16x16x32_bf16 v[88:91], v[160:163], v[136:139], v[88:91]
    ds_read_b128 v[120:123], v6 offset:4096
    ds_read_b128 v[124:127], v6 offset:6144
    v_mfma_f32_16x16x32_bf16 v[92:95], v[160:163], v[140:143], v[92:95]
    ds_read_b64_tr_b16 v[148:149], v7 offset:6144
    v_mfma_f32_16x16x32_bf16 v[96:99], v[164:167], v[128:131], v[96:99]
    ds_read_b64_tr_b16 v[150:151], v7 offset:6912
    v_mfma_f32_16x16x32_bf16 v[100:103], v[164:167], v[132:135], v[100:103]
    ds_read_b64_tr_b16 v[152:153], v8 offset:32
    v_mfma_f32_16x16x32_bf16 v[104:107], v[164:167], v[136:139], v[104:107]
    ds_read_b64_tr_b16 v[154:155], v8 offset:800
    v_mfma_f32_16x16x32_bf16 v[108:111], v[164:167], v[140:143], v[108:111]
    s_mov_b32 s63, s64
    s_add_u32 s64, s64, 32768
    s_cmp_ge_u32 s64, 98304
    s_cselect_b32 s64, 0, s64
    s_add_u32 s66, s66, 1
    s_cmp_lt_u32 s66, 10
    s_cbranch_scc1 K1_LOOP_F
    s_waitcnt lgkmcnt(0)
    s_lshl_b32 s61, s60, 8
    s_add_u32 s61, s61, 159744
    v_lshl_add_u32 v9, v0, 2, s61
    ds_read_b32 v152, v9
    v_lshlrev_b32 v10, 2, v14
    s_mul_i32 s62, s67, 384
    s_add_u32 s62, s62, 161792
    v_add_u32 v10, s62, v10
    ds_read_b32 v128, v10 offset:0
    ds_read_b32 v132, v10 offset:64
    ds_read_b32 v136, v10 offset:128
    ds_read_b32 v140, v10 offset:192
    ds_read_b32 v144, v10 offset:256
    ds_read_b32 v148, v10 offset:320
    v_lshl_add_u32 v9, v14, 2, s61
    ds_read_b32 v156, v9 offset:1024
    ds_read_b32 v157, v9 offset:1088
    ds_read_b32 v158, v9 offset:1152
    ds_read_b32 v159, v9 offset:1216
    v_mov_b32 v113, 0
    v_mov_b32 v117, 0
    v_mov_b32 v121, 0
    v_mov_b32 v125, 0
    v_mov_b32 v129, 0
    v_mov_b32 v133, 0
    v_mov_b32 v137, 0
    v_mov_b32 v141, 0
    v_mov_b32 v145, 0
    v_mov_b32 v149, 0
    v_mov_b32 v114, 0
    v_mov_b32 v118, 0
    v_mov_b32 v122, 0
    v_mov_b32 v126, 0
    v_mov_b32 v130, 0
    v_mov_b32 v134, 0
    v_mov_b32 v138, 0
    v_mov_b32 v142, 0
    v_mov_b32 v146, 0
    v_mov_b32 v150, 0
    v_mov_b32 v115, 0
    v_mov_b32 v119, 0
    v_mov_b32 v123, 0
    v_mov_b32 v127, 0
    v_mov_b32 v131, 0
    v_mov_b32 v135, 0
    v_mov_b32 v139, 0
    v_mov_b32 v143, 0
    v_mov_b32 v147, 0
    v_mov_b32 v151, 0
    v_cmp_eq_u32 s[72:73], 0, v15
    v_cmp_eq_u32 s[74:75], 1, v15
    v_cmp_eq_u32 s[76:77], 2, v15
    v_cmp_eq_u32 s[78:79], 3, v15
    s_waitcnt lgkmcnt(0)
    v_cndmask_b32 v112, 0, v152, s[72:73]
    v_cndmask_b32 v116, 0, v152, s[74:75]
    v_cndmask_b32 v120, 0, v152, s[76:77]
    v_cndmask_b32 v124, 0, v152, s[78:79]
    v_mfma_f32_16x16x32_bf16 v[16:19], v[128:131], v[112:115], v[16:19]
    v_mfma_f32_16x16x32_bf16 v[32:35], v[132:135], v[112:115], v[32:35]
    v_mfma_f32_16x16x32_bf16 v[48:51], v[136:139], v[112:115], v[48:51]
    v_mfma_f32_16x16x32_bf16 v[64:67], v[140:143], v[112:115], v[64:67]
    v_mfma_f32_16x16x32_bf16 v[80:83], v[144:147], v[112:115], v[80:83]
    v_mfma_f32_16x16x32_bf16 v[96:99], v[148:151], v[112:115], v[96:99]
    v_mfma_f32_16x16x32_bf16 v[20:23], v[128:131], v[116:119], v[20:23]
    v_mfma_f32_16x16x32_bf16 v[36:39], v[132:135], v[116:119], v[36:39]
    v_mfma_f32_16x16x32_bf16 v[52:55], v[136:139], v[116:119], v[52:55]
    v_mfma_f32_16x16x32_bf16 v[68:71], v[140:143], v[116:119], v[68:71]
    v_mfma_f32_16x16x32_bf16 v[84:87], v[144:147], v[116:119], v[84:87]
    v_mfma_f32_16x16x32_bf16 v[100:103], v[148:151], v[116:119], v[100:103]
    v_mfma_f32_16x16x32_bf16 v[24:27], v[128:131], v[120:123], v[24:27]
    v_mfma_f32_16x16x32_bf16 v[40:43], v[132:135], v[120:123], v[40:43]
    v_mfma_f32_16x16x32_bf16 v[56:59], v[136:139], v[120:123], v[56:59]
    v_mfma_f32_16x16x32_bf16 v[72:75], v[140:143], v[120:123], v[72:75]
    v_mfma_f32_16x16x32_bf16 v[88:91], v[144:147], v[120:123], v[88:91]
    v_mfma_f32_16x16x32_bf16 v[104:107], v[148:151], v[120:123], v[104:107]
    v_mfma_f32_16x16x32_bf16 v[28:31], v[128:131], v[124:127], v[28:31]
    v_mfma_f32_16x16x32_bf16 v[44:47], v[132:135], v[124:127], v[44:47]
    v_mfma_f32_16x16x32_bf16 v[60:63], v[136:139], v[124:127], v[60:63]
    v_mfma_f32_16x16x32_bf16 v[76:79], v[140:143], v[124:127], v[76:79]
    v_mfma_f32_16x16x32_bf16 v[92:95], v[144:147], v[124:127], v[92:95]
    v_mfma_f32_16x16x32_bf16 v[108:111], v[148:151], v[124:127], v[108:111]
    v_mul_f32 v116, v156, v156
    v_mul_f32 v112, 0xc0135761, v156
    v_mul_f32 v114, v112, v116
    v_rcp_f32 v116, v116
    v_mul_f32 v114, 0x3d372713, v114
    v_mul_f32 v122, v157, v157
    v_mul_f32 v118, 0xc0135761, v157
    v_mul_f32 v120, v118, v122
    v_rcp_f32 v122, v122
    v_mul_f32 v120, 0x3d372713, v120
    v_mul_f32 v128, v158, v158
    v_mul_f32 v124, 0xc0135761, v158
    v_mul_f32 v126, v124, v128
    v_rcp_f32 v128, v128
    v_mul_f32 v126, 0x3d372713, v126
    v_mul_f32 v134, v159, v159
    v_mul_f32 v130, 0xc0135761, v159
    v_mul_f32 v132, v130, v134
    v_rcp_f32 v134, v134
    v_mul_f32 v132, 0x3d372713, v132
    v_lshlrev_b32 v9, 4, v0
    s_lshl_b32 s61, s25, 2
    s_add_u32 s61, s61, s60
    s_mul_i32 s61, s61, 221184
    s_mul_i32 s62, s26, 12288
    s_add_u32 s61, s61, s62
    s_add_u32 s62, s61, 8192
    s_add_u32 s63, s61, 4096
    v_bfe_u32 v10, v0, 4, 1
    v_lshlrev_b32 v10, 10, v10
    v_lshl_add_u32 v10, v14, 4, v10
    v_lshrrev_b32 v11, 5, v0
    v_lshl_add_u32 v10, v11, 8, v10
    s_lshl_b32 s64, s67, 9
    s_add_u32 s63, s63, s64
    s_cmp_lg_u32 s67, 0
    s_cselect_b32 s61, s62, s61
    s_cbranch_scc1 K1_FE1
    v_pk_mul_f32 v[136:137], v[16:17], v[16:17]
    v_pk_mul_f32 v[138:139], v[18:19], v[18:19]
    v_pk_fma_f32 v[136:137], v[136:137], v[114:115], v[112:113] op_sel_hi:[1,0,0]
    v_pk_fma_f32 v[138:139], v[138:139], v[114:115], v[112:113] op_sel_hi:[1,0,0]
    v_pk_mul_f32 v[136:137], v[136:137], v[16:17]
    v_pk_mul_f32 v[138:139], v[138:139], v[18:19]
    v_exp_f32 v136, v136
    v_exp_f32 v137, v137
    v_exp_f32 v138, v138
    v_exp_f32 v139, v139
    v_pk_mul_f32 v[140:141], v[16:17], v[32:33]
    v_pk_mul_f32 v[142:143], v[18:19], v[34:35]
    v_pk_fma_f32 v[136:137], v[136:137], v[116:117], v[116:117] op_sel_hi:[1,0,0]
    v_pk_fma_f32 v[138:139], v[138:139], v[116:117], v[116:117] op_sel_hi:[1,0,0]
    v_rcp_f32 v136, v136
    v_rcp_f32 v137, v137
    v_rcp_f32 v138, v138
    v_rcp_f32 v139, v139
    v_pk_mul_f32 v[140:141], v[140:141], v[136:137]
    v_pk_mul_f32 v[142:143], v[142:143], v[138:139]
    v_cvt_pk_bf16_f32 v152, v140, v141
    v_cvt_pk_bf16_f32 v153, v142, v143
    v_pk_mul_f32 v[144:145], v[48:49], v[48:49]
    v_pk_mul_f32 v[146:147], v[50:51], v[50:51]
    v_pk_fma_f32 v[144:145], v[144:145], v[114:115], v[112:113] op_sel_hi:[1,0,0]
    v_pk_fma_f32 v[146:147], v[146:147], v[114:115], v[112:113] op_sel_hi:[1,0,0]
    v_pk_mul_f32 v[144:145], v[144:145], v[48:49]
    v_pk_mul_f32 v[146:147], v[146:147], v[50:51]
    v_exp_f32 v144, v144
    v_exp_f32 v145, v145
    v_exp_f32 v146, v146
    v_exp_f32 v147, v147
    v_pk_mul_f32 v[148:149], v[48:49], v[64:65]
    v_pk_mul_f32 v[150:151], v[50:51], v[66:67]
    v_pk_fma_f32 v[144:145], v[144:145], v[116:117], v[116:117] op_sel_hi:[1,0,0]
    v_pk_fma_f32 v[146:147], v[146:147], v[116:117], v[116:117] op_sel_hi:[1,0,0]
    v_rcp_f32 v144, v144
    v_rcp_f32 v145, v145
    v_rcp_f32 v146, v146
    v_rcp_f32 v147, v147
    v_pk_mul_f32 v[148:149], v[148:149], v[144:145]
    v_pk_mul_f32 v[150:151], v[150:151], v[146:147]
    v_cvt_pk_bf16_f32 v154, v148, v149
    v_cvt_pk_bf16_f32 v155, v150, v151
    v_pk_mul_f32 v[136:137], v[80:81], v[80:81]
    v_pk_mul_f32 v[138:139], v[82:83], v[82:83]
    v_pk_fma_f32 v[136:137], v[136:137], v[114:115], v[112:113] op_sel_hi:[1,0,0]
    v_pk_fma_f32 v[138:139], v[138:139], v[114:115], v[112:113] op_sel_hi:[1,0,0]
    v_pk_mul_f32 v[136:137], v[136:137], v[80:81]
    v_pk_mul_f32 v[138:139], v[138:139], v[82:83]
    v_exp_f32 v136, v136
    v_exp_f32 v137, v137
    v_exp_f32 v138, v138
    v_exp_f32 v139, v139
    v_pk_mul_f32 v[140:141], v[80:81], v[96:97]
    v_pk_mul_f32 v[142:143], v[82:83], v[98:99]
    v_pk_fma_f32 v[136:137], v[136:137], v[116:117], v[116:117] op_sel_hi:[1,0,0]
    v_pk_fma_f32 v[138:139], v[138:139], v[116:117], v[116:117] op_sel_hi:[1,0,0]
    v_rcp_f32 v136, v136
    v_rcp_f32 v137, v137
    v_rcp_f32 v138, v138
    v_rcp_f32 v139, v139
    v_pk_mul_f32 v[140:141], v[140:141], v[136:137]
    v_pk_mul_f32 v[142:143], v[142:143], v[138:139]
    v_cvt_pk_bf16_f32 v160, v140, v141
    v_cvt_pk_bf16_f32 v161, v142, v143
    buffer_store_dwordx4 v[152:155], v9, s[48:51], s61 offen offset:0 sc1
    v_pk_mul_f32 v[136:137], v[20:21], v[20:21]
    v_pk_mul_f32 v[138:139], v[22:23], v[22:23]
    v_pk_fma_f32 v[136:137], v[136:137], v[120:121], v[118:119] op_sel_hi:[1,0,0]
    v_pk_fma_f32 v[138:139], v[138:139], v[120:121], v[118:119] op_sel_hi:[1,0,0]
    v_pk_mul_f32 v[136:137], v[136:137], v[20:21]
    v_pk_mul_f32 v[138:139], v[138:139], v[22:23]
    v_exp_f32 v136, v136
    v_exp_f32 v137, v137
    v_exp_f32 v138, v138
    v_exp_f32 v139, v139
    v_pk_mul_f32 v[140:141], v[20:21], v[36:37]
    v_pk_mul_f32 v[142:143], v[22:23], v[38:39]
    v_pk_fma_f32 v[136:137], v[136:137], v[122:123], v[122:123] op_sel_hi:[1,0,0]
    v_pk_fma_f32 v[138:139], v[138:139], v[122:123], v[122:123] op_sel_hi:[1,0,0]
    v_rcp_f32 v136, v136
    v_rcp_f32 v137, v137
    v_rcp_f32 v138, v138
    v_rcp_f32 v139, v139
    v_pk_mul_f32 v[140:141], v[140:141], v[136:137]
    v_pk_mul_f32 v[142:143], v[142:143], v[138:139]
    v_cvt_pk_bf16_f32 v156, v140, v141
    v_cvt_pk_bf16_f32 v157, v142, v143
    v_pk_mul_f32 v[144:145], v[52:53], v[52:53]
    v_pk_mul_f32 v[146:147], v[54:55], v[54:55]
    v_pk_fma_f32 v[144:145], v[144:145], v[120:121], v[118:119] op_sel_hi:[1,0,0]
    v_pk_fma_f32 v[146:147], v[146:147], v[120:121], v[118:119] op_sel_hi:[1,0,0]
    v_pk_mul_f32 v[144:145], v[144:145], v[52:53]
    v_pk_mul_f32 v[146:147], v[146:147], v[54:55]
    v_exp_f32 v144, v144
    v_exp_f32 v145, v145
    v_exp_f32 v146, v146
    v_exp_f32 v147, v147
    v_pk_mul_f32 v[148:149], v[52:53], v[68:69]
    v_pk_mul_f32 v[150:151], v[54:55], v[70:71]
    v_pk_fma_f32 v[144:145], v[144:145], v[122:123], v[122:123] op_sel_hi:[1,0,0]
    v_pk_fma_f32 v[146:147], v[146:147], v[122:123], v[122:123] op_sel_hi:[1,0,0]
    v_rcp_f32 v144, v144
    v_rcp_f32 v145, v145
    v_rcp_f32 v146, v146
    v_rcp_f32 v147, v147
    v_pk_mul_f32 v[148:149], v[148:149], v[144:145]
    v_pk_mul_f32 v[150:151], v[150:151], v[146:147]
    v_cvt_pk_bf16_f32 v158, v148, v149
    v_cvt_pk_bf16_f32 v159, v150, v151
    v_pk_mul_f32 v[136:137], v[84:85], v[84:85]
    v_pk_mul_f32 v[138:139], v[86:87], v[86:87]
    v_pk_fma_f32 v[136:137], v[136:137], v[120:121], v[118:119] op_sel_hi:[1,0,0]
    v_pk_fma_f32 v[138:139], v[138:139], v[120:121], v[118:119] op_sel_hi:[1,0,0]
    v_pk_mul_f32 v[136:137], v[136:137], v[84:85]
    v_pk_mul_f32 v[138:139], v[138:139], v[86:87]
    v_exp_f32 v136, v136
    v_exp_f32 v137, v137
    v_exp_f32 v138, v138
    v_exp_f32 v139, v139
    v_pk_mul_f32 v[140:141], v[84:85], v[100:101]
    v_pk_mul_f32 v[142:143], v[86:87], v[102:103]
    v_pk_fma_f32 v[136:137], v[136:137], v[122:123], v[122:123] op_sel_hi:[1,0,0]
    v_pk_fma_f32 v[138:139], v[138:139], v[122:123], v[122:123] op_sel_hi:[1,0,0]
    v_rcp_f32 v136, v136
    v_rcp_f32 v137, v137
    v_rcp_f32 v138, v138
    v_rcp_f32 v139, v139
    v_pk_mul_f32 v[140:141], v[140:141], v[136:137]
    v_pk_mul_f32 v[142:143], v[142:143], v[138:139]
    v_cvt_pk_bf16_f32 v162, v140, v141
    v_cvt_pk_bf16_f32 v163, v142, v143
    buffer_store_dwordx4 v[156:159], v9, s[48:51], s61 offen offset:1024 sc1
    v_permlane16_swap_b32 v160, v162
    v_permlane16_swap_b32 v161, v163
    buffer_store_dwordx4 v[160:163], v10, s[48:51], s63 offen offset:0 sc1
    v_pk_mul_f32 v[136:137], v[24:25], v[24:25]
    v_pk_mul_f32 v[138:139], v[26:27], v[26:27]
    v_pk_fma_f32 v[136:137], v[136:137], v[126:127], v[124:125] op_sel_hi:[1,0,0]
    v_pk_fma_f32 v[138:139], v[138:139], v[126:127], v[124:125] op_sel_hi:[1,0,0]
    v_pk_mul_f32 v[136:137], v[136:137], v[24:25]
    v_pk_mul_f32 v[138:139], v[138:139], v[26:27]
    v_exp_f32 v136, v136
    v_exp_f32 v137, v137
    v_exp_f32 v138, v138
    v_exp_f32 v139, v139
    v_pk_mul_f32 v[140:141], v[24:25], v[40:41]
    v_pk_mul_f32 v[142:143], v[26:27], v[42:43]
    v_pk_fma_f32 v[136:137], v[136:137], v[128:129], v[128:129] op_sel_hi:[1,0,0]
    v_pk_fma_f32 v[138:139], v[138:139], v[128:129], v[128:129] op_sel_hi:[1,0,0]
    v_rcp_f32 v136, v136
    v_rcp_f32 v137, v137
    v_rcp_f32 v138, v138
    v_rcp_f32 v139, v139
    v_pk_mul_f32 v[140:141], v[140:141], v[136:137]
    v_pk_mul_f32 v[142:143], v[142:143], v[138:139]
    v_cvt_pk_bf16_f32 v152, v140, v141
    v_cvt_pk_bf16_f32 v153, v142, v143
    v_pk_mul_f32 v[144:145], v[56:57], v[56:57]
    v_pk_mul_f32 v[146:147], v[58:59], v[58:59]
    v_pk_fma_f32 v[144:145], v[144:145], v[126:127], v[124:125] op_sel_hi:[1,0,0]
    v_pk_fma_f32 v[146:147], v[146:147], v[126:127], v[124:125] op_sel_hi:[1,0,0]
    v_pk_mul_f32 v[144:145], v[144:145], v[56:57]
    v_pk_mul_f32 v[146:147], v[146:147], v[58:59]
    v_exp_f32 v144, v144
    v_exp_f32 v145, v145
    v_exp_f32 v146, v146
    v_exp_f32 v147, v147
    v_pk_mul_f32 v[148:149], v[56:57], v[72:73]
    v_pk_mul_f32 v[150:151], v[58:59], v[74:75]
    v_pk_fma_f32 v[144:145], v[144:145], v[128:129], v[128:129] op_sel_hi:[1,0,0]
    v_pk_fma_f32 v[146:147], v[146:147], v[128:129], v[128:129] op_sel_hi:[1,0,0]
    v_rcp_f32 v144, v144
    v_rcp_f32 v145, v145
    v_rcp_f32 v146, v146
    v_rcp_f32 v147, v147
    v_pk_mul_f32 v[148:149], v[148:149], v[144:145]
    v_pk_mul_f32 v[150:151], v[150:151], v[146:147]
    v_cvt_pk_bf16_f32 v154, v148, v149
    v_cvt_pk_bf16_f32 v155, v150, v151
    v_pk_mul_f32 v[136:137], v[88:89], v[88:89]
    v_pk_mul_f32 v[138:139], v[90:91], v[90:91]
    v_pk_fma_f32 v[136:137], v[136:137], v[126:127], v[124:125] op_sel_hi:[1,0,0]
    v_pk_fma_f32 v[138:139], v[138:139], v[126:127], v[124:125] op_sel_hi:[1,0,0]
    v_pk_mul_f32 v[136:137], v[136:137], v[88:89]
    v_pk_mul_f32 v[138:139], v[138:139], v[90:91]
    v_exp_f32 v136, v136
    v_exp_f32 v137, v137
    v_exp_f32 v138, v138
    v_exp_f32 v139, v139
    v_pk_mul_f32 v[140:141], v[88:89], v[104:105]
    v_pk_mul_f32 v[142:143], v[90:91], v[106:107]
    v_pk_fma_f32 v[136:137], v[136:137], v[128:129], v[128:129] op_sel_hi:[1,0,0]
    v_pk_fma_f32 v[138:139], v[138:139], v[128:129], v[128:129] op_sel_hi:[1,0,0]
    v_rcp_f32 v136, v136
    v_rcp_f32 v137, v137
    v_rcp_f32 v138, v138
    v_rcp_f32 v139, v139
    v_pk_mul_f32 v[140:141], v[140:141], v[136:137]
    v_pk_mul_f32 v[142:143], v[142:143], v[138:139]
    v_cvt_pk_bf16_f32 v164, v140, v141
    v_cvt_pk_bf16_f32 v165, v142, v143
    buffer_store_dwordx4 v[152:155], v9, s[48:51], s61 offen offset:2048 sc1
    v_pk_mul_f32 v[136:137], v[28:29], v[28:29]
    v_pk_mul_f32 v[138:139], v[30:31], v[30:31]
    v_pk_fma_f32 v[136:137], v[136:137], v[132:133], v[130:131] op_sel_hi:[1,0,0]
    v_pk_fma_f32 v[138:139], v[138:139], v[132:133], v[130:131] op_sel_hi:[1,0,0]
    v_pk_mul_f32 v[136:137], v[136:137], v[28:29]
    v_pk_mul_f32 v[138:139], v[138:139], v[30:31]
    v_exp_f32 v136, v136
    v_exp_f32 v137, v137
    v_exp_f32 v138, v138
    v_exp_f32 v139, v139
    v_pk_mul_f32 v[140:141], v[28:29], v[44:45]
    v_pk_mul_f32 v[142:143], v[30:31], v[46:47]
    v_pk_fma_f32 v[136:137], v[136:137], v[134:135], v[134:135] op_sel_hi:[1,0,0]
    v_pk_fma_f32 v[138:139], v[138:139], v[134:135], v[134:135] op_sel_hi:[1,0,0]
    v_rcp_f32 v136, v136
    v_rcp_f32 v137, v137
    v_rcp_f32 v138, v138
    v_rcp_f32 v139, v139
    v_pk_mul_f32 v[140:141], v[140:141], v[136:137]
    v_pk_mul_f32 v[142:143], v[142:143], v[138:139]
    v_cvt_pk_bf16_f32 v156, v140, v141
    v_cvt_pk_bf16_f32 v157, v142, v143
    v_pk_mul_f32 v[144:145], v[60:61], v[60:61]
    v_pk_mul_f32 v[146:147], v[62:63], v[62:63]
    v_pk_fma_f32 v[144:145], v[144:145], v[132:133], v[130:131] op_sel_hi:[1,0,0]
    v_pk_fma_f32 v[146:147], v[146:147], v[132:133], v[130:131] op_sel_hi:[1,0,0]
    v_pk_mul_f32 v[144:145], v[144:145], v[60:61]
    v_pk_mul_f32 v[146:147], v[146:147], v[62:63]
    v_exp_f32 v144, v144
    v_exp_f32 v145, v145
    v_exp_f32 v146, v146
    v_exp_f32 v147, v147
    v_pk_mul_f32 v[148:149], v[60:61], v[76:77]
    v_pk_mul_f32 v[150:151], v[62:63], v[78:79]
    v_pk_fma_f32 v[144:145], v[144:145], v[134:135], v[134:135] op_sel_hi:[1,0,0]
    v_pk_fma_f32 v[146:147], v[146:147], v[134:135], v[134:135] op_sel_hi:[1,0,0]
    v_rcp_f32 v144, v144
    v_rcp_f32 v145, v145
    v_rcp_f32 v146, v146
    v_rcp_f32 v147, v147
    v_pk_mul_f32 v[148:149], v[148:149], v[144:145]
    v_pk_mul_f32 v[150:151], v[150:151], v[146:147]
    v_cvt_pk_bf16_f32 v158, v148, v149
    v_cvt_pk_bf16_f32 v159, v150, v151
    v_pk_mul_f32 v[136:137], v[92:93], v[92:93]
    v_pk_mul_f32 v[138:139], v[94:95], v[94:95]
    v_pk_fma_f32 v[136:137], v[136:137], v[132:133], v[130:131] op_sel_hi:[1,0,0]
    v_pk_fma_f32 v[138:139], v[138:139], v[132:133], v[130:131] op_sel_hi:[1,0,0]
    v_pk_mul_f32 v[136:137], v[136:137], v[92:93]
    v_pk_mul_f32 v[138:139], v[138:139], v[94:95]
    v_exp_f32 v136, v136
    v_exp_f32 v137, v137
    v_exp_f32 v138, v138
    v_exp_f32 v139, v139
    v_pk_mul_f32 v[140:141], v[92:93], v[108:109]
    v_pk_mul_f32 v[142:143], v[94:95], v[110:111]
    v_pk_fma_f32 v[136:137], v[136:137], v[134:135], v[134:135] op_sel_hi:[1,0,0]
    v_pk_fma_f32 v[138:139], v[138:139], v[134:135], v[134:135] op_sel_hi:[1,0,0]
    v_rcp_f32 v136, v136
    v_rcp_f32 v137, v137
    v_rcp_f32 v138, v138
    v_rcp_f32 v139, v139
    v_pk_mul_f32 v[140:141], v[140:141], v[136:137]
    v_pk_mul_f32 v[142:143], v[142:143], v[138:139]
    v_cvt_pk_bf16_f32 v166, v140, v141
    v_cvt_pk_bf16_f32 v167, v142, v143
    buffer_store_dwordx4 v[156:159], v9, s[48:51], s61 offen offset:3072 sc1
    v_permlane16_swap_b32 v164, v166
    v_permlane16_swap_b32 v165, v167
    buffer_store_dwordx4 v[164:167], v10, s[48:51], s63 offen offset:2048 sc1
    s_waitcnt vmcnt(0)
    s_barrier
    s_endpgm
K1_FE1:
    v_pk_mul_f32 v[136:137], v[16:17], v[16:17]
    v_pk_mul_f32 v[138:139], v[18:19], v[18:19]
    v_pk_fma_f32 v[136:137], v[136:137], v[114:115], v[112:113] op_sel_hi:[1,0,0]
    v_pk_fma_f32 v[138:139], v[138:139], v[114:115], v[112:113] op_sel_hi:[1,0,0]
    v_pk_mul_f32 v[136:137], v[136:137], v[16:17]
    v_pk_mul_f32 v[138:139], v[138:139], v[18:19]
    v_exp_f32 v136, v136
    v_exp_f32 v137, v137
    v_exp_f32 v138, v138
    v_exp_f32 v139, v139
    v_pk_mul_f32 v[140:141], v[16:17], v[32:33]
    v_pk_mul_f32 v[142:143], v[18:19], v[34:35]
    v_pk_fma_f32 v[136:137], v[136:137], v[116:117], v[116:117] op_sel_hi:[1,0,0]
    v_pk_fma_f32 v[138:139], v[138:139], v[116:117], v[116:117] op_sel_hi:[1,0,0]
    v_rcp_f32 v136, v136
    v_rcp_f32 v137, v137
    v_rcp_f32 v138, v138
    v_rcp_f32 v139, v139
    v_pk_mul_f32 v[140:141], v[140:141], v[136:137]
    v_pk_mul_f32 v[142:143], v[142:143], v[138:139]
    v_cvt_pk_bf16_f32 v160, v140, v141
    v_cvt_pk_bf16_f32 v161, v142, v143
    v_pk_mul_f32 v[144:145], v[48:49], v[48:49]
    v_pk_mul_f32 v[146:147], v[50:51], v[50:51]
    v_pk_fma_f32 v[144:145], v[144:145], v[114:115], v[112:113] op_sel_hi:[1,0,0]
    v_pk_fma_f32 v[146:147], v[146:147], v[114:115], v[112:113] op_sel_hi:[1,0,0]
    v_pk_mul_f32 v[144:145], v[144:145], v[48:49]
    v_pk_mul_f32 v[146:147], v[146:147], v[50:51]
    v_exp_f32 v144, v144
    v_exp_f32 v145, v145
    v_exp_f32 v146, v146
    v_exp_f32 v147, v147
    v_pk_mul_f32 v[148:149], v[48:49], v[64:65]
    v_pk_mul_f32 v[150:151], v[50:51], v[66:67]
    v_pk_fma_f32 v[144:145], v[144:145], v[116:117], v[116:117] op_sel_hi:[1,0,0]
    v_pk_fma_f32 v[146:147], v[146:147], v[116:117], v[116:117] op_sel_hi:[1,0,0]
    v_rcp_f32 v144, v144
    v_rcp_f32 v145, v145
    v_rcp_f32 v146, v146
    v_rcp_f32 v147, v147
    v_pk_mul_f32 v[148:149], v[148:149], v[144:145]
    v_pk_mul_f32 v[150:151], v[150:151], v[146:147]
    v_cvt_pk_bf16_f32 v152, v148, v149
    v_cvt_pk_bf16_f32 v153, v150, v151
    v_pk_mul_f32 v[136:137], v[80:81], v[80:81]
    v_pk_mul_f32 v[138:139], v[82:83], v[82:83]
    v_pk_fma_f32 v[136:137], v[136:137], v[114:115], v[112:113] op_sel_hi:[1,0,0]
    v_pk_fma_f32 v[138:139], v[138:139], v[114:115], v[112:113] op_sel_hi:[1,0,0]
    v_pk_mul_f32 v[136:137], v[136:137], v[80:81]
    v_pk_mul_f32 v[138:139], v[138:139], v[82:83]
    v_exp_f32 v136, v136
    v_exp_f32 v137, v137
    v_exp_f32 v138, v138
    v_exp_f32 v139, v139
    v_pk_mul_f32 v[140:141], v[80:81], v[96:97]
    v_pk_mul_f32 v[142:143], v[82:83], v[98:99]
    v_pk_fma_f32 v[136:137], v[136:137], v[116:117], v[116:117] op_sel_hi:[1,0,0]
    v_pk_fma_f32 v[138:139], v[138:139], v[116:117], v[116:117] op_sel_hi:[1,0,0]
    v_rcp_f32 v136, v136
    v_rcp_f32 v137, v137
    v_rcp_f32 v138, v138
    v_rcp_f32 v139, v139
    v_pk_mul_f32 v[140:141], v[140:141], v[136:137]
    v_pk_mul_f32 v[142:143], v[142:143], v[138:139]
    v_cvt_pk_bf16_f32 v154, v140, v141
    v_cvt_pk_bf16_f32 v155, v142, v143
    buffer_store_dwordx4 v[152:155], v9, s[48:51], s61 offen offset:0 sc1
    v_pk_mul_f32 v[136:137], v[20:21], v[20:21]
    v_pk_mul_f32 v[138:139], v[22:23], v[22:23]
    v_pk_fma_f32 v[136:137], v[136:137], v[120:121], v[118:119] op_sel_hi:[1,0,0]
    v_pk_fma_f32 v[138:139], v[138:139], v[120:121], v[118:119] op_sel_hi:[1,0,0]
    v_pk_mul_f32 v[136:137], v[136:137], v[20:21]
    v_pk_mul_f32 v[138:139], v[138:139], v[22:23]
    v_exp_f32 v136, v136
    v_exp_f32 v137, v137
    v_exp_f32 v138, v138
    v_exp_f32 v139, v139
    v_pk_mul_f32 v[140:141], v[20:21], v[36:37]
    v_pk_mul_f32 v[142:143], v[22:23], v[38:39]
    v_pk_fma_f32 v[136:137], v[136:137], v[122:123], v[122:123] op_sel_hi:[1,0,0]
    v_pk_fma_f32 v[138:139], v[138:139], v[122:123], v[122:123] op_sel_hi:[1,0,0]
    v_rcp_f32 v136, v136
    v_rcp_f32 v137, v137
    v_rcp_f32 v138, v138
    v_rcp_f32 v139, v139
    v_pk_mul_f32 v[140:141], v[140:141], v[136:137]
    v_pk_mul_f32 v[142:143], v[142:143], v[138:139]
    v_cvt_pk_bf16_f32 v162, v140, v141
    v_cvt_pk_bf16_f32 v163, v142, v143
    v_pk_mul_f32 v[144:145], v[52:53], v[52:53]
    v_pk_mul_f32 v[146:147], v[54:55], v[54:55]
    v_pk_fma_f32 v[144:145], v[144:145], v[120:121], v[118:119] op_sel_hi:[1,0,0]
    v_pk_fma_f32 v[146:147], v[146:147], v[120:121], v[118:119] op_sel_hi:[1,0,0]
    v_pk_mul_f32 v[144:145], v[144:145], v[52:53]
    v_pk_mul_f32 v[146:147], v[146:147], v[54:55]
    v_exp_f32 v144, v144
    v_exp_f32 v145, v145
    v_exp_f32 v146, v146
    v_exp_f32 v147, v147
    v_pk_mul_f32 v[148:149], v[52:53], v[68:69]
    v_pk_mul_f32 v[150:151], v[54:55], v[70:71]
    v_pk_fma_f32 v[144:145], v[144:145], v[122:123], v[122:123] op_sel_hi:[1,0,0]
    v_pk_fma_f32 v[146:147], v[146:147], v[122:123], v[122:123] op_sel_hi:[1,0,0]
    v_rcp_f32 v144, v144
    v_rcp_f32 v145, v145
    v_rcp_f32 v146, v146
    v_rcp_f32 v147, v147
    v_pk_mul_f32 v[148:149], v[148:149], v[144:145]
    v_pk_mul_f32 v[150:151], v[150:151], v[146:147]
    v_cvt_pk_bf16_f32 v156, v148, v149
    v_cvt_pk_bf16_f32 v157, v150, v151
    v_pk_mul_f32 v[136:137], v[84:85], v[84:85]
    v_pk_mul_f32 v[138:139], v[86:87], v[86:87]
    v_pk_fma_f32 v[136:137], v[136:137], v[120:121], v[118:119] op_sel_hi:[1,0,0]
    v_pk_fma_f32 v[138:139], v[138:139], v[120:121], v[118:119] op_sel_hi:[1,0,0]
    v_pk_mul_f32 v[136:137], v[136:137], v[84:85]
    v_pk_mul_f32 v[138:139], v[138:139], v[86:87]
    v_exp_f32 v136, v136
    v_exp_f32 v137, v137
    v_exp_f32 v138, v138
    v_exp_f32 v139, v139
    v_pk_mul_f32 v[140:141], v[84:85], v[100:101]
    v_pk_mul_f32 v[142:143], v[86:87], v[102:103]
    v_pk_fma_f32 v[136:137], v[136:137], v[122:123], v[122:123] op_sel_hi:[1,0,0]
    v_pk_fma_f32 v[138:139], v[138:139], v[122:123], v[122:123] op_sel_hi:[1,0,0]
    v_rcp_f32 v136, v136
    v_rcp_f32 v137, v137
    v_rcp_f32 v138, v138
    v_rcp_f32 v139, v139
    v_pk_mul_f32 v[140:141], v[140:141], v[136:137]
    v_pk_mul_f32 v[142:143], v[142:143], v[138:139]
    v_cvt_pk_bf16_f32 v158, v140, v141
    v_cvt_pk_bf16_f32 v159, v142, v143
    buffer_store_dwordx4 v[156:159], v9, s[48:51], s61 offen offset:1024 sc1
    v_permlane16_swap_b32 v160, v162
    v_permlane16_swap_b32 v161, v163
    buffer_store_dwordx4 v[160:163], v10, s[48:51], s63 offen offset:0 sc1
    v_pk_mul_f32 v[136:137], v[24:25], v[24:25]
    v_pk_mul_f32 v[138:139], v[26:27], v[26:27]
    v_pk_fma_f32 v[136:137], v[136:137], v[126:127], v[124:125] op_sel_hi:[1,0,0]
    v_pk_fma_f32 v[138:139], v[138:139], v[126:127], v[124:125] op_sel_hi:[1,0,0]
    v_pk_mul_f32 v[136:137], v[136:137], v[24:25]
    v_pk_mul_f32 v[138:139], v[138:139], v[26:27]
    v_exp_f32 v136, v136
    v_exp_f32 v137, v137
    v_exp_f32 v138, v138
    v_exp_f32 v139, v139
    v_pk_mul_f32 v[140:141], v[24:25], v[40:41]
    v_pk_mul_f32 v[142:143], v[26:27], v[42:43]
    v_pk_fma_f32 v[136:137], v[136:137], v[128:129], v[128:129] op_sel_hi:[1,0,0]
    v_pk_fma_f32 v[138:139], v[138:139], v[128:129], v[128:129] op_sel_hi:[1,0,0]
    v_rcp_f32 v136, v136
    v_rcp_f32 v137, v137
    v_rcp_f32 v138, v138
    v_rcp_f32 v139, v139
    v_pk_mul_f32 v[140:141], v[140:141], v[136:137]
    v_pk_mul_f32 v[142:143], v[142:143], v[138:139]
    v_cvt_pk_bf16_f32 v164, v140, v141
    v_cvt_pk_bf16_f32 v165, v142, v143
    v_pk_mul_f32 v[144:145], v[56:57], v[56:57]
    v_pk_mul_f32 v[146:147], v[58:59], v[58:59]
    v_pk_fma_f32 v[144:145], v[144:145], v[126:127], v[124:125] op_sel_hi:[1,0,0]
    v_pk_fma_f32 v[146:147], v[146:147], v[126:127], v[124:125] op_sel_hi:[1,0,0]
    v_pk_mul_f32 v[144:145], v[144:145], v[56:57]
    v_pk_mul_f32 v[146:147], v[146:147], v[58:59]
    v_exp_f32 v144, v144
    v_exp_f32 v145, v145
    v_exp_f32 v146, v146
    v_exp_f32 v147, v147
    v_pk_mul_f32 v[148:149], v[56:57], v[72:73]
    v_pk_mul_f32 v[150:151], v[58:59], v[74:75]
    v_pk_fma_f32 v[144:145], v[144:145], v[128:129], v[128:129] op_sel_hi:[1,0,0]
    v_pk_fma_f32 v[146:147], v[146:147], v[128:129], v[128:129] op_sel_hi:[1,0,0]
    v_rcp_f32 v144, v144
    v_rcp_f32 v145, v145
    v_rcp_f32 v146, v146
    v_rcp_f32 v147, v147
    v_pk_mul_f32 v[148:149], v[148:149], v[144:145]
    v_pk_mul_f32 v[150:151], v[150:151], v[146:147]
    v_cvt_pk_bf16_f32 v152, v148, v149
    v_cvt_pk_bf16_f32 v153, v150, v151
    v_pk_mul_f32 v[136:137], v[88:89], v[88:89]
    v_pk_mul_f32 v[138:139], v[90:91], v[90:91]
    v_pk_fma_f32 v[136:137], v[136:137], v[126:127], v[124:125] op_sel_hi:[1,0,0]
    v_pk_fma_f32 v[138:139], v[138:139], v[126:127], v[124:125] op_sel_hi:[1,0,0]
    v_pk_mul_f32 v[136:137], v[136:137], v[88:89]
    v_pk_mul_f32 v[138:139], v[138:139], v[90:91]
    v_exp_f32 v136, v136
    v_exp_f32 v137, v137
    v_exp_f32 v138, v138
    v_exp_f32 v139, v139
    v_pk_mul_f32 v[140:141], v[88:89], v[104:105]
    v_pk_mul_f32 v[142:143], v[90:91], v[106:107]
    v_pk_fma_f32 v[136:137], v[136:137], v[128:129], v[128:129] op_sel_hi:[1,0,0]
    v_pk_fma_f32 v[138:139], v[138:139], v[128:129], v[128:129] op_sel_hi:[1,0,0]
    v_rcp_f32 v136, v136
    v_rcp_f32 v137, v137
    v_rcp_f32 v138, v138
    v_rcp_f32 v139, v139
    v_pk_mul_f32 v[140:141], v[140:141], v[136:137]
    v_pk_mul_f32 v[142:143], v[142:143], v[138:139]
    v_cvt_pk_bf16_f32 v154, v140, v141
    v_cvt_pk_bf16_f32 v155, v142, v143
    buffer_store_dwordx4 v[152:155], v9, s[48:51], s61 offen offset:2048 sc1
    v_pk_mul_f32 v[136:137], v[28:29], v[28:29]
    v_pk_mul_f32 v[138:139], v[30:31], v[30:31]
    v_pk_fma_f32 v[136:137], v[136:137], v[132:133], v[130:131] op_sel_hi:[1,0,0]
    v_pk_fma_f32 v[138:139], v[138:139], v[132:133], v[130:131] op_sel_hi:[1,0,0]
    v_pk_mul_f32 v[136:137], v[136:137], v[28:29]
    v_pk_mul_f32 v[138:139], v[138:139], v[30:31]
    v_exp_f32 v136, v136
    v_exp_f32 v137, v137
    v_exp_f32 v138, v138
    v_exp_f32 v139, v139
    v_pk_mul_f32 v[140:141], v[28:29], v[44:45]
    v_pk_mul_f32 v[142:143], v[30:31], v[46:47]
    v_pk_fma_f32 v[136:137], v[136:137], v[134:135], v[134:135] op_sel_hi:[1,0,0]
    v_pk_fma_f32 v[138:139], v[138:139], v[134:135], v[134:135] op_sel_hi:[1,0,0]
    v_rcp_f32 v136, v136
    v_rcp_f32 v137, v137
    v_rcp_f32 v138, v138
    v_rcp_f32 v139, v139
    v_pk_mul_f32 v[140:141], v[140:141], v[136:137]
    v_pk_mul_f32 v[142:143], v[142:143], v[138:139]
    v_cvt_pk_bf16_f32 v166, v140, v141
    v_cvt_pk_bf16_f32 v167, v142, v143
    v_pk_mul_f32 v[144:145], v[60:61], v[60:61]
    v_pk_mul_f32 v[146:147], v[62:63], v[62:63]
    v_pk_fma_f32 v[144:145], v[144:145], v[132:133], v[130:131] op_sel_hi:[1,0,0]
    v_pk_fma_f32 v[146:147], v[146:147], v[132:133], v[130:131] op_sel_hi:[1,0,0]
    v_pk_mul_f32 v[144:145], v[144:145], v[60:61]
    v_pk_mul_f32 v[146:147], v[146:147], v[62:63]
    v_exp_f32 v144, v144
    v_exp_f32 v145, v145
    v_exp_f32 v146, v146
    v_exp_f32 v147, v147
    v_pk_mul_f32 v[148:149], v[60:61], v[76:77]
    v_pk_mul_f32 v[150:151], v[62:63], v[78:79]
    v_pk_fma_f32 v[144:145], v[144:145], v[134:135], v[134:135] op_sel_hi:[1,0,0]
    v_pk_fma_f32 v[146:147], v[146:147], v[134:135], v[134:135] op_sel_hi:[1,0,0]
    v_rcp_f32 v144, v144
    v_rcp_f32 v145, v145
    v_rcp_f32 v146, v146
    v_rcp_f32 v147, v147
    v_pk_mul_f32 v[148:149], v[148:149], v[144:145]
    v_pk_mul_f32 v[150:151], v[150:151], v[146:147]
    v_cvt_pk_bf16_f32 v156, v148, v149
    v_cvt_pk_bf16_f32 v157, v150, v151
    v_pk_mul_f32 v[136:137], v[92:93], v[92:93]
    v_pk_mul_f32 v[138:139], v[94:95], v[94:95]
    v_pk_fma_f32 v[136:137], v[136:137], v[132:133], v[130:131] op_sel_hi:[1,0,0]
    v_pk_fma_f32 v[138:139], v[138:139], v[132:133], v[130:131] op_sel_hi:[1,0,0]
    v_pk_mul_f32 v[136:137], v[136:137], v[92:93]
    v_pk_mul_f32 v[138:139], v[138:139], v[94:95]
    v_exp_f32 v136, v136
    v_exp_f32 v137, v137
    v_exp_f32 v138, v138
    v_exp_f32 v139, v139
    v_pk_mul_f32 v[140:141], v[92:93], v[108:109]
    v_pk_mul_f32 v[142:143], v[94:95], v[110:111]
    v_pk_fma_f32 v[136:137], v[136:137], v[134:135], v[134:135] op_sel_hi:[1,0,0]
    v_pk_fma_f32 v[138:139], v[138:139], v[134:135], v[134:135] op_sel_hi:[1,0,0]
    v_rcp_f32 v136, v136
    v_rcp_f32 v137, v137
    v_rcp_f32 v138, v138
    v_rcp_f32 v139, v139
    v_pk_mul_f32 v[140:141], v[140:141], v[136:137]
    v_pk_mul_f32 v[142:143], v[142:143], v[138:139]
    v_cvt_pk_bf16_f32 v158, v140, v141
    v_cvt_pk_bf16_f32 v159, v142, v143
    buffer_store_dwordx4 v[156:159], v9, s[48:51], s61 offen offset:3072 sc1
    v_permlane16_swap_b32 v164, v166
    v_permlane16_swap_b32 v165, v167
    buffer_store_dwordx4 v[164:167], v10, s[48:51], s63 offen offset:2048 sc1
    s_waitcnt vmcnt(0)
    s_barrier
    s_endpgm
K1_Q:
    s_sub_u32 s26, s26, 18
    v_and_b32 v14, 15, v0
    v_lshrrev_b32 v15, 4, v0
    v_bfe_u32 v9, v0, 1, 3
    v_xor_b32 v9, v9, v15
    s_lshl_b32 s61, s60, 13
    v_lshl_add_u32 v10, v14, 7, s61
    v_lshl_add_u32 v2, v9, 4, v10
    v_xor_b32 v9, 4, v9
    v_lshl_add_u32 v3, v9, 4, v10
    v_bfe_u32 v9, v0, 2, 2
    v_lshl_add_u32 v9, v15, 3, v9
    v_mul_u32_u24 v9, 320, v9
    v_and_b32 v10, 3, v0
    v_lshl_add_u32 v9, v10, 3, v9
    v_bfe_u32 v10, v0, 4, 1
    v_lshlrev_b32 v10, 5, v10
    s_mul_i32 s62, s67, 160
    v_add_u32 v9, s62, v9
    v_add_u32 v11, v9, v10
    v_sub_u32 v12, v9, v10
    s_cmp_eq_u32 s67, 0
    s_cselect_b64 s[68:69], -1, 0
    v_cndmask_b32 v4, v12, v11, s[68:69]
    v_cndmask_b32 v5, v11, v12, s[68:69]
    v_mov_b32 v16, 0
    v_mov_b32 v17, 0
    v_mov_b32 v18, 0
    v_mov_b32 v19, 0
    v_mov_b32 v20, 0
    v_mov_b32 v21, 0
    v_mov_b32 v22, 0
    v_mov_b32 v23, 0
    v_mov_b32 v24, 0
    v_mov_b32 v25, 0
    v_mov_b32 v26, 0
    v_mov_b32 v27, 0
    v_mov_b32 v28, 0
    v_mov_b32 v29, 0
    v_mov_b32 v30, 0
    v_mov_b32 v31, 0
    v_mov_b32 v32, 0
    v_mov_b32 v33, 0
    v_mov_b32 v34, 0
    v_mov_b32 v35, 0
    v_mov_b32 v36, 0
    v_mov_b32 v37, 0
    v_mov_b32 v38, 0
    v_mov_b32 v39, 0
    v_mov_b32 v40, 0
    v_mov_b32 v41, 0
    v_mov_b32 v42, 0
    v_mov_b32 v43, 0
    v_mov_b32 v44, 0
    v_mov_b32 v45, 0
    v_mov_b32 v46, 0
    v_mov_b32 v47, 0
    v_mov_b32 v48, 0
    v_mov_b32 v49, 0
    v_mov_b32 v50, 0
    v_mov_b32 v51, 0
    v_mov_b32 v52, 0
    v_mov_b32 v53, 0
    v_mov_b32 v54, 0
    v_mov_b32 v55, 0
    v_mov_b32 v56, 0
    v_mov_b32 v57, 0
    v_mov_b32 v58, 0
    v_mov_b32 v59, 0
    v_mov_b32 v60, 0
    v_mov_b32 v61, 0
    v_mov_b32 v62, 0
    v_mov_b32 v63, 0
    v_mov_b32 v64, 0
    v_mov_b32 v65, 0
    v_mov_b32 v66, 0
    v_mov_b32 v67, 0
    v_mov_b32 v68, 0
    v_mov_b32 v69, 0
    v_mov_b32 v70, 0
    v_mov_b32 v71, 0
    v_mov_b32 v72, 0
    v_mov_b32 v73, 0
    v_mov_b32 v74, 0
    v_mov_b32 v75, 0
    v_mov_b32 v76, 0
    v_mov_b32 v77, 0
    v_mov_b32 v78, 0
    v_mov_b32 v79, 0
    v_mov_b32 v80, 0
    v_mov_b32 v81, 0
    v_mov_b32 v82, 0
    v_mov_b32 v83, 0
    v_mov_b32 v84, 0
    v_mov_b32 v85, 0
    v_mov_b32 v86, 0
    v_mov_b32 v87, 0
    v_mov_b32 v88, 0
    v_mov_b32 v89, 0
    v_mov_b32 v90, 0
    v_mov_b32 v91, 0
    v_mov_b32 v92, 0
    v_mov_b32 v93, 0
    v_mov_b32 v94, 0
    v_mov_b32 v95, 0
    s_mov_b32 s63, 0
    s_mov_b32 s64, 32768
    s_mov_b32 s65, 98304
    s_mov_b32 s66, 0
    s_cmp_eq_u32 s67, 0
    s_cselect_b32 s71, 8, 99
    v_add_u32 v7, s65, v4
    v_add_u32 v8, s65, v5
    s_barrier
    v_add_u32 v6, s63, v2
    ds_read_b64_tr_b16 v[144:145], v7 offset:0
    ds_read_b64_tr_b16 v[146:147], v7 offset:1280
    ds_read_b128 v[112:115], v6 offset:0
    ds_read_b128 v[116:119], v6 offset:2048
    ds_read_b128 v[120:123], v6 offset:4096
    ds_read_b128 v[124:127], v6 offset:6144
    ds_read_b64_tr_b16 v[148:149], v8 offset:32
    ds_read_b64_tr_b16 v[150:151], v8 offset:1312
    ds_read_b64_tr_b16 v[152:153], v7 offset:64
    ds_read_b64_tr_b16 v[154:155], v7 offset:1344
K1_LOOP_Q:
    s_waitcnt lgkmcnt(0)
    v_mfma_f32_16x16x32_bf16 v[16:19], v[144:147], v[112:115], v[16:19]
    v_mfma_f32_16x16x32_bf16 v[20:23], v[144:147], v[116:119], v[20:23]
    ds_read_b64_tr_b16 v[156:157], v8 offset:96
    v_mfma_f32_16x16x32_bf16 v[24:27], v[144:147], v[120:123], v[24:27]
    ds_read_b64_tr_b16 v[158:159], v8 offset:1376
    v_mfma_f32_16x16x32_bf16 v[28:31], v[144:147], v[124:127], v[28:31]
    ds_read_b64_tr_b16 v[160:161], v7 offset:128
    v_mfma_f32_16x16x32_bf16 v[32:35], v[148:151], v[112:115], v[32:35]
    ds_read_b64_tr_b16 v[162:163], v7 offset:1408
    v_mfma_f32_16x16x32_bf16 v[36:39], v[148:151], v[116:119], v[36:39]
    v_mfma_f32_16x16x32_bf16 v[40:43], v[148:151], v[120:123], v[40:43]
    v_mfma_f32_16x16x32_bf16 v[44:47], v[148:151], v[124:127], v[44:47]
    v_mfma_f32_16x16x32_bf16 v[48:51], v[152:155], v[112:115], v[48:51]
    v_mfma_f32_16x16x32_bf16 v[52:55], v[152:155], v[116:119], v[52:55]
    v_mfma_f32_16x16x32_bf16 v[56:59], v[152:155], v[120:123], v[56:59]
    v_mfma_f32_16x16x32_bf16 v[60:63], v[152:155], v[124:127], v[60:63]
    s_waitcnt lgkmcnt(0)
    v_mfma_f32_16x16x32_bf16 v[64:67], v[156:159], v[112:115], v[64:67]
    v_mfma_f32_16x16x32_bf16 v[68:71], v[156:159], v[116:119], v[68:71]
    s_barrier
    s_add_u32 s65, s65, 12288
    s_cmp_ge_u32 s65, 159744
    v_mfma_f32_16x16x32_bf16 v[72:75], v[156:159], v[120:123], v[72:75]
    s_cselect_b32 s65, 98304, s65
    v_add_u32 v7, s65, v4
    v_mfma_f32_16x16x32_bf16 v[76:79], v[156:159], v[124:127], v[76:79]
    v_add_u32 v8, s65, v5
    v_add_u32 v6, s63, v3
    v_mfma_f32_16x16x32_bf16 v[80:83], v[160:163], v[112:115], v[80:83]
    ds_read_b64_tr_b16 v[144:145], v7 offset:0
    ds_read_b64_tr_b16 v[146:147], v7 offset:1280
    v_mfma_f32_16x16x32_bf16 v[84:87], v[160:163], v[116:119], v[84:87]
    ds_read_b128 v[128:131], v6 offset:0
    ds_read_b128 v[132:135], v6 offset:2048
    v_mfma_f32_16x16x32_bf16 v[88:91], v[160:163], v[120:123], v[88:91]
    ds_read_b128 v[136:139], v6 offset:4096
    ds_read_b128 v[140:143], v6 offset:6144
    v_mfma_f32_16x16x32_bf16 v[92:95], v[160:163], v[124:127], v[92:95]
    ds_read_b64_tr_b16 v[148:149], v8 offset:32
    ds_read_b64_tr_b16 v[150:151], v8 offset:1312
    ds_read_b64_tr_b16 v[152:153], v7 offset:64
    ds_read_b64_tr_b16 v[154:155], v7 offset:1344
    s_waitcnt lgkmcnt(0)
    v_mfma_f32_16x16x32_bf16 v[16:19], v[144:147], v[128:131], v[16:19]
    v_mfma_f32_16x16x32_bf16 v[20:23], v[144:147], v[132:135], v[20:23]
    ds_read_b64_tr_b16 v[156:157], v8 offset:96
    v_mfma_f32_16x16x32_bf16 v[24:27], v[144:147], v[136:139], v[24:27]
    ds_read_b64_tr_b16 v[158:159], v8 offset:1376
    v_mfma_f32_16x16x32_bf16 v[28:31], v[144:147], v[140:143], v[28:31]
    ds_read_b64_tr_b16 v[160:161], v7 offset:128
    v_mfma_f32_16x16x32_bf16 v[32:35], v[148:151], v[128:131], v[32:35]
    ds_read_b64_tr_b16 v[162:163], v7 offset:1408
    v_mfma_f32_16x16x32_bf16 v[36:39], v[148:151], v[132:135], v[36:39]
    v_mfma_f32_16x16x32_bf16 v[40:43], v[148:151], v[136:139], v[40:43]
    v_mfma_f32_16x16x32_bf16 v[44:47], v[148:151], v[140:143], v[44:47]
    v_mfma_f32_16x16x32_bf16 v[48:51], v[152:155], v[128:131], v[48:51]
    v_mfma_f32_16x16x32_bf16 v[52:55], v[152:155], v[132:135], v[52:55]
    v_mfma_f32_16x16x32_bf16 v[56:59], v[152:155], v[136:139], v[56:59]
    v_mfma_f32_16x16x32_bf16 v[60:63], v[152:155], v[140:143], v[60:63]
    s_waitcnt lgkmcnt(0)
    v_mfma_f32_16x16x32_bf16 v[64:67], v[156:159], v[128:131], v[64:67]
    v_mfma_f32_16x16x32_bf16 v[68:71], v[156:159], v[132:135], v[68:71]
    s_barrier
    s_add_u32 s65, s65, 12288
    s_cmp_ge_u32 s65, 159744
    v_mfma_f32_16x16x32_bf16 v[72:75], v[156:159], v[136:139], v[72:75]
    s_cselect_b32 s65, 98304, s65
    v_add_u32 v7, s65, v4
    v_mfma_f32_16x16x32_bf16 v[76:79], v[156:159], v[140:143], v[76:79]
    v_add_u32 v8, s65, v5
    v_add_u32 v6, s64, v2
    v_mfma_f32_16x16x32_bf16 v[80:83], v[160:163], v[128:131], v[80:83]
    ds_read_b64_tr_b16 v[144:145], v7 offset:0
    ds_read_b64_tr_b16 v[146:147], v7 offset:1280
    v_mfma_f32_16x16x32_bf16 v[84:87], v[160:163], v[132:135], v[84:87]
    ds_read_b128 v[112:115], v6 offset:0
    ds_read_b128 v[116:119], v6 offset:2048
    v_mfma_f32_16x16x32_bf16 v[88:91], v[160:163], v[136:139], v[88:91]
    ds_read_b128 v[120:123], v6 offset:4096
    ds_read_b128 v[124:127], v6 offset:6144
    v_mfma_f32_16x16x32_bf16 v[92:95], v[160:163], v[140:143], v[92:95]
    ds_read_b64_tr_b16 v[148:149], v8 offset:32
    ds_read_b64_tr_b16 v[150:151], v8 offset:1312
    ds_read_b64_tr_b16 v[152:153], v7 offset:64
    ds_read_b64_tr_b16 v[154:155], v7 offset:1344
    s_mov_b32 s63, s64
    s_add_u32 s64, s64, 32768
    s_cmp_ge_u32 s64, 98304
    s_cselect_b32 s64, 0, s64
    s_add_u32 s66, s66, 1
    s_cmp_lt_u32 s66, 10
    s_cbranch_scc1 K1_LOOP_Q
    s_waitcnt lgkmcnt(0)
    s_lshl_b32 s61, s60, 8
    s_add_u32 s61, s61, 159744
    v_lshl_add_u32 v9, v0, 2, s61
    ds_read_b32 v152, v9
    v_lshlrev_b32 v10, 2, v14
    s_mul_i32 s62, s67, 320
    s_add_u32 s62, s62, 161792
    v_add_u32 v10, s62, v10
    ds_read_b32 v128, v10 offset:0
    ds_read_b32 v132, v10 offset:64
    ds_read_b32 v136, v10 offset:128
    ds_read_b32 v140, v10 offset:192
    ds_read_b32 v144, v10 offset:256
    v_lshl_add_u32 v9, v14, 2, s61
    ds_read_b32 v156, v9 offset:1024
    ds_read_b32 v157, v9 offset:1088
    ds_read_b32 v158, v9 offset:1152
    ds_read_b32 v159, v9 offset:1216
    v_mov_b32 v113, 0
    v_mov_b32 v117, 0
    v_mov_b32 v121, 0
    v_mov_b32 v125, 0
    v_mov_b32 v129, 0
    v_mov_b32 v133, 0
    v_mov_b32 v137, 0
    v_mov_b32 v141, 0
    v_mov_b32 v145, 0
    v_mov_b32 v114, 0
    v_mov_b32 v118, 0
    v_mov_b32 v122, 0
    v_mov_b32 v126, 0
    v_mov_b32 v130, 0
    v_mov_b32 v134, 0
    v_mov_b32 v138, 0
    v_mov_b32 v142, 0
    v_mov_b32 v146, 0
    v_mov_b32 v115, 0
    v_mov_b32 v119, 0
    v_mov_b32 v123, 0
    v_mov_b32 v127, 0
    v_mov_b32 v131, 0
    v_mov_b32 v135, 0
    v_mov_b32 v139, 0
    v_mov_b32 v143, 0
    v_mov_b32 v147, 0
    v_cmp_eq_u32 s[72:73], 0, v15
    v_cmp_eq_u32 s[74:75], 1, v15
    v_cmp_eq_u32 s[76:77], 2, v15
    v_cmp_eq_u32 s[78:79], 3, v15
    s_waitcnt lgkmcnt(0)
    v_cndmask_b32 v112, 0, v152, s[72:73]
    v_cndmask_b32 v116, 0, v152, s[74:75]
    v_cndmask_b32 v120, 0, v152, s[76:77]
    v_cndmask_b32 v124, 0, v152, s[78:79]
    v_mfma_f32_16x16x32_bf16 v[16:19], v[128:131], v[112:115], v[16:19]
    v_mfma_f32_16x16x32_bf16 v[20:23], v[128:131], v[116:119], v[20:23]
    v_mfma_f32_16x16x32_bf16 v[24:27], v[128:131], v[120:123], v[24:27]
    v_mfma_f32_16x16x32_bf16 v[28:31], v[128:131], v[124:127], v[28:31]
    v_mfma_f32_16x16x32_bf16 v[32:35], v[132:135], v[112:115], v[32:35]
    v_mfma_f32_16x16x32_bf16 v[36:39], v[132:135], v[116:119], v[36:39]
    v_mfma_f32_16x16x32_bf16 v[40:43], v[132:135], v[120:123], v[40:43]
    v_mfma_f32_16x16x32_bf16 v[44:47], v[132:135], v[124:127], v[44:47]
    v_mfma_f32_16x16x32_bf16 v[48:51], v[136:139], v[112:115], v[48:51]
    v_mfma_f32_16x16x32_bf16 v[52:55], v[136:139], v[116:119], v[52:55]
    v_mfma_f32_16x16x32_bf16 v[56:59], v[136:139], v[120:123], v[56:59]
    v_mfma_f32_16x16x32_bf16 v[60:63], v[136:139], v[124:127], v[60:63]
    v_mfma_f32_16x16x32_bf16 v[64:67], v[140:143], v[112:115], v[64:67]
    v_mfma_f32_16x16x32_bf16 v[68:71], v[140:143], v[116:119], v[68:71]
    v_mfma_f32_16x16x32_bf16 v[72:75], v[140:143], v[120:123], v[72:75]
    v_mfma_f32_16x16x32_bf16 v[76:79], v[140:143], v[124:127], v[76:79]
    v_mfma_f32_16x16x32_bf16 v[80:83], v[144:147], v[112:115], v[80:83]
    v_mfma_f32_16x16x32_bf16 v[84:87], v[144:147], v[116:119], v[84:87]
    v_mfma_f32_16x16x32_bf16 v[88:91], v[144:147], v[120:123], v[88:91]
    v_mfma_f32_16x16x32_bf16 v[92:95], v[144:147], v[124:127], v[92:95]
    v_mov_b32 v112, v156
    v_mul_f32 v114, 0x3fb8aa3b, v156
    v_mov_b32 v116, v157
    v_mul_f32 v118, 0x3fb8aa3b, v157
    v_mov_b32 v120, v158
    v_mul_f32 v122, 0x3fb8aa3b, v158
    v_mov_b32 v124, v159
    v_mul_f32 v126, 0x3fb8aa3b, v159
    v_lshlrev_b32 v9, 4, v14
    v_bfe_u32 v10, v0, 4, 1
    v_lshl_add_u32 v9, v10, 9, v9
    v_lshrrev_b32 v10, 5, v0
    v_lshl_add_u32 v9, v10, 8, v9
    s_lshl_b32 s61, s25, 2
    s_add_u32 s61, s61, s60
    s_mul_i32 s61, s61, 81920
    s_mul_i32 s62, s26, 20480
    s_add_u32 s61, s61, s62
    s_mul_i32 s62, s67, 10240
    s_add_u32 s61, s61, s62
    s_add_u32 s61, s61, 7077888
    s_mov_b32 s64, 0x358637bd
    s_mov_b32 s65, 0x358637bd
    s_add_u32 s62, s61, 0
    v_pk_mul_f32 v[128:129], v[16:17], v[114:115] op_sel_hi:[1,0]
    v_pk_mul_f32 v[130:131], v[18:19], v[114:115] op_sel_hi:[1,0]
    v_pk_fma_f32 v[132:133], v[16:17], v[112:113], s[64:65] op_sel_hi:[1,0,1]
    v_pk_fma_f32 v[134:135], v[18:19], v[112:113], s[64:65] op_sel_hi:[1,0,1]
    v_exp_f32 v128, v128 clamp
    v_exp_f32 v129, v129 clamp
    v_exp_f32 v130, v130 clamp
    v_exp_f32 v131, v131 clamp
    v_max_f32 v132, s64, v132
    v_max_f32 v133, s64, v133
    v_max_f32 v134, s64, v134
    v_max_f32 v135, s64, v135
    v_pk_add_f32 v[128:129], v[128:129], v[132:133]
    v_pk_add_f32 v[130:131], v[130:131], v[134:135]
    v_cvt_pk_bf16_f32 v144, v128, v129
    v_cvt_pk_bf16_f32 v145, v130, v131
    v_pk_mul_f32 v[128:129], v[20:21], v[118:119] op_sel_hi:[1,0]
    v_pk_mul_f32 v[130:131], v[22:23], v[118:119] op_sel_hi:[1,0]
    v_pk_fma_f32 v[132:133], v[20:21], v[116:117], s[64:65] op_sel_hi:[1,0,1]
    v_pk_fma_f32 v[134:135], v[22:23], v[116:117], s[64:65] op_sel_hi:[1,0,1]
    v_exp_f32 v128, v128 clamp
    v_exp_f32 v129, v129 clamp
    v_exp_f32 v130, v130 clamp
    v_exp_f32 v131, v131 clamp
    v_max_f32 v132, s64, v132
    v_max_f32 v133, s64, v133
    v_max_f32 v134, s64, v134
    v_max_f32 v135, s64, v135
    v_pk_add_f32 v[128:129], v[128:129], v[132:133]
    v_pk_add_f32 v[130:131], v[130:131], v[134:135]
    v_cvt_pk_bf16_f32 v146, v128, v129
    v_cvt_pk_bf16_f32 v147, v130, v131
    s_nop 0
    v_permlane32_swap_b32 v144, v146
    v_permlane32_swap_b32 v145, v147
    buffer_store_dwordx4 v[144:147], v9, s[48:51], s62 offen offset:0 sc1
    v_pk_mul_f32 v[128:129], v[24:25], v[122:123] op_sel_hi:[1,0]
    v_pk_mul_f32 v[130:131], v[26:27], v[122:123] op_sel_hi:[1,0]
    v_pk_fma_f32 v[132:133], v[24:25], v[120:121], s[64:65] op_sel_hi:[1,0,1]
    v_pk_fma_f32 v[134:135], v[26:27], v[120:121], s[64:65] op_sel_hi:[1,0,1]
    v_exp_f32 v128, v128 clamp
    v_exp_f32 v129, v129 clamp
    v_exp_f32 v130, v130 clamp
    v_exp_f32 v131, v131 clamp
    v_max_f32 v132, s64, v132
    v_max_f32 v133, s64, v133
    v_max_f32 v134, s64, v134
    v_max_f32 v135, s64, v135
    v_pk_add_f32 v[128:129], v[128:129], v[132:133]
    v_pk_add_f32 v[130:131], v[130:131], v[134:135]
    v_cvt_pk_bf16_f32 v148, v128, v129
    v_cvt_pk_bf16_f32 v149, v130, v131
    v_pk_mul_f32 v[128:129], v[28:29], v[126:127] op_sel_hi:[1,0]
    v_pk_mul_f32 v[130:131], v[30:31], v[126:127] op_sel_hi:[1,0]
    v_pk_fma_f32 v[132:133], v[28:29], v[124:125], s[64:65] op_sel_hi:[1,0,1]
    v_pk_fma_f32 v[134:135], v[30:31], v[124:125], s[64:65] op_sel_hi:[1,0,1]
    v_exp_f32 v128, v128 clamp
    v_exp_f32 v129, v129 clamp
    v_exp_f32 v130, v130 clamp
    v_exp_f32 v131, v131 clamp
    v_max_f32 v132, s64, v132
    v_max_f32 v133, s64, v133
    v_max_f32 v134, s64, v134
    v_max_f32 v135, s64, v135
    v_pk_add_f32 v[128:129], v[128:129], v[132:133]
    v_pk_add_f32 v[130:131], v[130:131], v[134:135]
    v_cvt_pk_bf16_f32 v150, v128, v129
    v_cvt_pk_bf16_f32 v151, v130, v131
    s_nop 0
    v_permlane32_swap_b32 v148, v150
    v_permlane32_swap_b32 v149, v151
    buffer_store_dwordx4 v[148:151], v9, s[48:51], s62 offen offset:1024 sc1
    s_add_u32 s62, s61, 2048
    v_pk_mul_f32 v[128:129], v[32:33], v[114:115] op_sel_hi:[1,0]
    v_pk_mul_f32 v[130:131], v[34:35], v[114:115] op_sel_hi:[1,0]
    v_pk_fma_f32 v[132:133], v[32:33], v[112:113], s[64:65] op_sel_hi:[1,0,1]
    v_pk_fma_f32 v[134:135], v[34:35], v[112:113], s[64:65] op_sel_hi:[1,0,1]
    v_exp_f32 v128, v128 clamp
    v_exp_f32 v129, v129 clamp
    v_exp_f32 v130, v130 clamp
    v_exp_f32 v131, v131 clamp
    v_max_f32 v132, s64, v132
    v_max_f32 v133, s64, v133
    v_max_f32 v134, s64, v134
    v_max_f32 v135, s64, v135
    v_pk_add_f32 v[128:129], v[128:129], v[132:133]
    v_pk_add_f32 v[130:131], v[130:131], v[134:135]
    v_cvt_pk_bf16_f32 v152, v128, v129
    v_cvt_pk_bf16_f32 v153, v130, v131
    v_pk_mul_f32 v[128:129], v[36:37], v[118:119] op_sel_hi:[1,0]
    v_pk_mul_f32 v[130:131], v[38:39], v[118:119] op_sel_hi:[1,0]
    v_pk_fma_f32 v[132:133], v[36:37], v[116:117], s[64:65] op_sel_hi:[1,0,1]
    v_pk_fma_f32 v[134:135], v[38:39], v[116:117], s[64:65] op_sel_hi:[1,0,1]
    v_exp_f32 v128, v128 clamp
    v_exp_f32 v129, v129 clamp
    v_exp_f32 v130, v130 clamp
    v_exp_f32 v131, v131 clamp
    v_max_f32 v132, s64, v132
    v_max_f32 v133, s64, v133
    v_max_f32 v134, s64, v134
    v_max_f32 v135, s64, v135
    v_pk_add_f32 v[128:129], v[128:129], v[132:133]
    v_pk_add_f32 v[130:131], v[130:131], v[134:135]
    v_cvt_pk_bf16_f32 v154, v128, v129
    v_cvt_pk_bf16_f32 v155, v130, v131
    s_nop 0
    v_permlane32_swap_b32 v152, v154
    v_permlane32_swap_b32 v153, v155
    buffer_store_dwordx4 v[152:155], v9, s[48:51], s62 offen offset:0 sc1
    v_pk_mul_f32 v[128:129], v[40:41], v[122:123] op_sel_hi:[1,0]
    v_pk_mul_f32 v[130:131], v[42:43], v[122:123] op_sel_hi:[1,0]
    v_pk_fma_f32 v[132:133], v[40:41], v[120:121], s[64:65] op_sel_hi:[1,0,1]
    v_pk_fma_f32 v[134:135], v[42:43], v[120:121], s[64:65] op_sel_hi:[1,0,1]
    v_exp_f32 v128, v128 clamp
    v_exp_f32 v129, v129 clamp
    v_exp_f32 v130, v130 clamp
    v_exp_f32 v131, v131 clamp
    v_max_f32 v132, s64, v132
    v_max_f32 v133, s64, v133
    v_max_f32 v134, s64, v134
    v_max_f32 v135, s64, v135
    v_pk_add_f32 v[128:129], v[128:129], v[132:133]
    v_pk_add_f32 v[130:131], v[130:131], v[134:135]
    v_cvt_pk_bf16_f32 v156, v128, v129
    v_cvt_pk_bf16_f32 v157, v130, v131
    v_pk_mul_f32 v[128:129], v[44:45], v[126:127] op_sel_hi:[1,0]
    v_pk_mul_f32 v[130:131], v[46:47], v[126:127] op_sel_hi:[1,0]
    v_pk_fma_f32 v[132:133], v[44:45], v[124:125], s[64:65] op_sel_hi:[1,0,1]
    v_pk_fma_f32 v[134:135], v[46:47], v[124:125], s[64:65] op_sel_hi:[1,0,1]
    v_exp_f32 v128, v128 clamp
    v_exp_f32 v129, v129 clamp
    v_exp_f32 v130, v130 clamp
    v_exp_f32 v131, v131 clamp
    v_max_f32 v132, s64, v132
    v_max_f32 v133, s64, v133
    v_max_f32 v134, s64, v134
    v_max_f32 v135, s64, v135
    v_pk_add_f32 v[128:129], v[128:129], v[132:133]
    v_pk_add_f32 v[130:131], v[130:131], v[134:135]
    v_cvt_pk_bf16_f32 v158, v128, v129
    v_cvt_pk_bf16_f32 v159, v130, v131
    s_nop 0
    v_permlane32_swap_b32 v156, v158
    v_permlane32_swap_b32 v157, v159
    buffer_store_dwordx4 v[156:159], v9, s[48:51], s62 offen offset:1024 sc1
    s_add_u32 s62, s61, 4096
    v_pk_mul_f32 v[128:129], v[48:49], v[114:115] op_sel_hi:[1,0]
    v_pk_mul_f32 v[130:131], v[50:51], v[114:115] op_sel_hi:[1,0]
    v_pk_fma_f32 v[132:133], v[48:49], v[112:113], s[64:65] op_sel_hi:[1,0,1]
    v_pk_fma_f32 v[134:135], v[50:51], v[112:113], s[64:65] op_sel_hi:[1,0,1]
    v_exp_f32 v128, v128 clamp
    v_exp_f32 v129, v129 clamp
    v_exp_f32 v130, v130 clamp
    v_exp_f32 v131, v131 clamp
    v_max_f32 v132, s64, v132
    v_max_f32 v133, s64, v133
    v_max_f32 v134, s64, v134
    v_max_f32 v135, s64, v135
    v_pk_add_f32 v[128:129], v[128:129], v[132:133]
    v_pk_add_f32 v[130:131], v[130:131], v[134:135]
    v_cvt_pk_bf16_f32 v144, v128, v129
    v_cvt_pk_bf16_f32 v145, v130, v131
    v_pk_mul_f32 v[128:129], v[52:53], v[118:119] op_sel_hi:[1,0]
    v_pk_mul_f32 v[130:131], v[54:55], v[118:119] op_sel_hi:[1,0]
    v_pk_fma_f32 v[132:133], v[52:53], v[116:117], s[64:65] op_sel_hi:[1,0,1]
    v_pk_fma_f32 v[134:135], v[54:55], v[116:117], s[64:65] op_sel_hi:[1,0,1]
    v_exp_f32 v128, v128 clamp
    v_exp_f32 v129, v129 clamp
    v_exp_f32 v130, v130 clamp
    v_exp_f32 v131, v131 clamp
    v_max_f32 v132, s64, v132
    v_max_f32 v133, s64, v133
    v_max_f32 v134, s64, v134
    v_max_f32 v135, s64, v135
    v_pk_add_f32 v[128:129], v[128:129], v[132:133]
    v_pk_add_f32 v[130:131], v[130:131], v[134:135]
    v_cvt_pk_bf16_f32 v146, v128, v129
    v_cvt_pk_bf16_f32 v147, v130, v131
    s_nop 0
    v_permlane32_swap_b32 v144, v146
    v_permlane32_swap_b32 v145, v147
    buffer_store_dwordx4 v[144:147], v9, s[48:51], s62 offen offset:0 sc1
    v_pk_mul_f32 v[128:129], v[56:57], v[122:123] op_sel_hi:[1,0]
    v_pk_mul_f32 v[130:131], v[58:59], v[122:123] op_sel_hi:[1,0]
    v_pk_fma_f32 v[132:133], v[56:57], v[120:121], s[64:65] op_sel_hi:[1,0,1]
    v_pk_fma_f32 v[134:135], v[58:59], v[120:121], s[64:65] op_sel_hi:[1,0,1]
    v_exp_f32 v128, v128 clamp
    v_exp_f32 v129, v129 clamp
    v_exp_f32 v130, v130 clamp
    v_exp_f32 v131, v131 clamp
    v_max_f32 v132, s64, v132
    v_max_f32 v133, s64, v133
    v_max_f32 v134, s64, v134
    v_max_f32 v135, s64, v135
    v_pk_add_f32 v[128:129], v[128:129], v[132:133]
    v_pk_add_f32 v[130:131], v[130:131], v[134:135]
    v_cvt_pk_bf16_f32 v148, v128, v129
    v_cvt_pk_bf16_f32 v149, v130, v131
    v_pk_mul_f32 v[128:129], v[60:61], v[126:127] op_sel_hi:[1,0]
    v_pk_mul_f32 v[130:131], v[62:63], v[126:127] op_sel_hi:[1,0]
    v_pk_fma_f32 v[132:133], v[60:61], v[124:125], s[64:65] op_sel_hi:[1,0,1]
    v_pk_fma_f32 v[134:135], v[62:63], v[124:125], s[64:65] op_sel_hi:[1,0,1]
    v_exp_f32 v128, v128 clamp
    v_exp_f32 v129, v129 clamp
    v_exp_f32 v130, v130 clamp
    v_exp_f32 v131, v131 clamp
    v_max_f32 v132, s64, v132
    v_max_f32 v133, s64, v133
    v_max_f32 v134, s64, v134
    v_max_f32 v135, s64, v135
    v_pk_add_f32 v[128:129], v[128:129], v[132:133]
    v_pk_add_f32 v[130:131], v[130:131], v[134:135]
    v_cvt_pk_bf16_f32 v150, v128, v129
    v_cvt_pk_bf16_f32 v151, v130, v131
    s_nop 0
    v_permlane32_swap_b32 v148, v150
    v_permlane32_swap_b32 v149, v151
    buffer_store_dwordx4 v[148:151], v9, s[48:51], s62 offen offset:1024 sc1
    s_add_u32 s62, s61, 6144
    v_pk_mul_f32 v[128:129], v[64:65], v[114:115] op_sel_hi:[1,0]
    v_pk_mul_f32 v[130:131], v[66:67], v[114:115] op_sel_hi:[1,0]
    v_pk_fma_f32 v[132:133], v[64:65], v[112:113], s[64:65] op_sel_hi:[1,0,1]
    v_pk_fma_f32 v[134:135], v[66:67], v[112:113], s[64:65] op_sel_hi:[1,0,1]
    v_exp_f32 v128, v128 clamp
    v_exp_f32 v129, v129 clamp
    v_exp_f32 v130, v130 clamp
    v_exp_f32 v131, v131 clamp
    v_max_f32 v132, s64, v132
    v_max_f32 v133, s64, v133
    v_max_f32 v134, s64, v134
    v_max_f32 v135, s64, v135
    v_pk_add_f32 v[128:129], v[128:129], v[132:133]
    v_pk_add_f32 v[130:131], v[130:131], v[134:135]
    v_cvt_pk_bf16_f32 v152, v128, v129
    v_cvt_pk_bf16_f32 v153, v130, v131
    v_pk_mul_f32 v[128:129], v[68:69], v[118:119] op_sel_hi:[1,0]
    v_pk_mul_f32 v[130:131], v[70:71], v[118:119] op_sel_hi:[1,0]
    v_pk_fma_f32 v[132:133], v[68:69], v[116:117], s[64:65] op_sel_hi:[1,0,1]
    v_pk_fma_f32 v[134:135], v[70:71], v[116:117], s[64:65] op_sel_hi:[1,0,1]
    v_exp_f32 v128, v128 clamp
    v_exp_f32 v129, v129 clamp
    v_exp_f32 v130, v130 clamp
    v_exp_f32 v131, v131 clamp
    v_max_f32 v132, s64, v132
    v_max_f32 v133, s64, v133
    v_max_f32 v134, s64, v134
    v_max_f32 v135, s64, v135
    v_pk_add_f32 v[128:129], v[128:129], v[132:133]
    v_pk_add_f32 v[130:131], v[130:131], v[134:135]
    v_cvt_pk_bf16_f32 v154, v128, v129
    v_cvt_pk_bf16_f32 v155, v130, v131
    s_nop 0
    v_permlane32_swap_b32 v152, v154
    v_permlane32_swap_b32 v153, v155
    buffer_store_dwordx4 v[152:155], v9, s[48:51], s62 offen offset:0 sc1
    v_pk_mul_f32 v[128:129], v[72:73], v[122:123] op_sel_hi:[1,0]
    v_pk_mul_f32 v[130:131], v[74:75], v[122:123] op_sel_hi:[1,0]
    v_pk_fma_f32 v[132:133], v[72:73], v[120:121], s[64:65] op_sel_hi:[1,0,1]
    v_pk_fma_f32 v[134:135], v[74:75], v[120:121], s[64:65] op_sel_hi:[1,0,1]
    v_exp_f32 v128, v128 clamp
    v_exp_f32 v129, v129 clamp
    v_exp_f32 v130, v130 clamp
    v_exp_f32 v131, v131 clamp
    v_max_f32 v132, s64, v132
    v_max_f32 v133, s64, v133
    v_max_f32 v134, s64, v134
    v_max_f32 v135, s64, v135
    v_pk_add_f32 v[128:129], v[128:129], v[132:133]
    v_pk_add_f32 v[130:131], v[130:131], v[134:135]
    v_cvt_pk_bf16_f32 v156, v128, v129
    v_cvt_pk_bf16_f32 v157, v130, v131
    v_pk_mul_f32 v[128:129], v[76:77], v[126:127] op_sel_hi:[1,0]
    v_pk_mul_f32 v[130:131], v[78:79], v[126:127] op_sel_hi:[1,0]
    v_pk_fma_f32 v[132:133], v[76:77], v[124:125], s[64:65] op_sel_hi:[1,0,1]
    v_pk_fma_f32 v[134:135], v[78:79], v[124:125], s[64:65] op_sel_hi:[1,0,1]
    v_exp_f32 v128, v128 clamp
    v_exp_f32 v129, v129 clamp
    v_exp_f32 v130, v130 clamp
    v_exp_f32 v131, v131 clamp
    v_max_f32 v132, s64, v132
    v_max_f32 v133, s64, v133
    v_max_f32 v134, s64, v134
    v_max_f32 v135, s64, v135
    v_pk_add_f32 v[128:129], v[128:129], v[132:133]
    v_pk_add_f32 v[130:131], v[130:131], v[134:135]
    v_cvt_pk_bf16_f32 v158, v128, v129
    v_cvt_pk_bf16_f32 v159, v130, v131
    s_nop 0
    v_permlane32_swap_b32 v156, v158
    v_permlane32_swap_b32 v157, v159
    buffer_store_dwordx4 v[156:159], v9, s[48:51], s62 offen offset:1024 sc1
    s_add_u32 s62, s61, 8192
    v_pk_mul_f32 v[128:129], v[80:81], v[114:115] op_sel_hi:[1,0]
    v_pk_mul_f32 v[130:131], v[82:83], v[114:115] op_sel_hi:[1,0]
    v_pk_fma_f32 v[132:133], v[80:81], v[112:113], s[64:65] op_sel_hi:[1,0,1]
    v_pk_fma_f32 v[134:135], v[82:83], v[112:113], s[64:65] op_sel_hi:[1,0,1]
    v_exp_f32 v128, v128 clamp
    v_exp_f32 v129, v129 clamp
    v_exp_f32 v130, v130 clamp
    v_exp_f32 v131, v131 clamp
    v_max_f32 v132, s64, v132
    v_max_f32 v133, s64, v133
    v_max_f32 v134, s64, v134
    v_max_f32 v135, s64, v135
    v_pk_add_f32 v[128:129], v[128:129], v[132:133]
    v_pk_add_f32 v[130:131], v[130:131], v[134:135]
    v_cvt_pk_bf16_f32 v144, v128, v129
    v_cvt_pk_bf16_f32 v145, v130, v131
    v_pk_mul_f32 v[128:129], v[84:85], v[118:119] op_sel_hi:[1,0]
    v_pk_mul_f32 v[130:131], v[86:87], v[118:119] op_sel_hi:[1,0]
    v_pk_fma_f32 v[132:133], v[84:85], v[116:117], s[64:65] op_sel_hi:[1,0,1]
    v_pk_fma_f32 v[134:135], v[86:87], v[116:117], s[64:65] op_sel_hi:[1,0,1]
    v_exp_f32 v128, v128 clamp
    v_exp_f32 v129, v129 clamp
    v_exp_f32 v130, v130 clamp
    v_exp_f32 v131, v131 clamp
    v_max_f32 v132, s64, v132
    v_max_f32 v133, s64, v133
    v_max_f32 v134, s64, v134
    v_max_f32 v135, s64, v135
    v_pk_add_f32 v[128:129], v[128:129], v[132:133]
    v_pk_add_f32 v[130:131], v[130:131], v[134:135]
    v_cvt_pk_bf16_f32 v146, v128, v129
    v_cvt_pk_bf16_f32 v147, v130, v131
    s_nop 0
    v_permlane32_swap_b32 v144, v146
    v_permlane32_swap_b32 v145, v147
    buffer_store_dwordx4 v[144:147], v9, s[48:51], s62 offen offset:0 sc1
    v_pk_mul_f32 v[128:129], v[88:89], v[122:123] op_sel_hi:[1,0]
    v_pk_mul_f32 v[130:131], v[90:91], v[122:123] op_sel_hi:[1,0]
    v_pk_fma_f32 v[132:133], v[88:89], v[120:121], s[64:65] op_sel_hi:[1,0,1]
    v_pk_fma_f32 v[134:135], v[90:91], v[120:121], s[64:65] op_sel_hi:[1,0,1]
    v_exp_f32 v128, v128 clamp
    v_exp_f32 v129, v129 clamp
    v_exp_f32 v130, v130 clamp
    v_exp_f32 v131, v131 clamp
    v_max_f32 v132, s64, v132
    v_max_f32 v133, s64, v133
    v_max_f32 v134, s64, v134
    v_max_f32 v135, s64, v135
    v_pk_add_f32 v[128:129], v[128:129], v[132:133]
    v_pk_add_f32 v[130:131], v[130:131], v[134:135]
    v_cvt_pk_bf16_f32 v148, v128, v129
    v_cvt_pk_bf16_f32 v149, v130, v131
    v_pk_mul_f32 v[128:129], v[92:93], v[126:127] op_sel_hi:[1,0]
    v_pk_mul_f32 v[130:131], v[94:95], v[126:127] op_sel_hi:[1,0]
    v_pk_fma_f32 v[132:133], v[92:93], v[124:125], s[64:65] op_sel_hi:[1,0,1]
    v_pk_fma_f32 v[134:135], v[94:95], v[124:125], s[64:65] op_sel_hi:[1,0,1]
    v_exp_f32 v128, v128 clamp
    v_exp_f32 v129, v129 clamp
    v_exp_f32 v130, v130 clamp
    v_exp_f32 v131, v131 clamp
    v_max_f32 v132, s64, v132
    v_max_f32 v133, s64, v133
    v_max_f32 v134, s64, v134
    v_max_f32 v135, s64, v135
    v_pk_add_f32 v[128:129], v[128:129], v[132:133]
    v_pk_add_f32 v[130:131], v[130:131], v[134:135]
    v_cvt_pk_bf16_f32 v150, v128, v129
    v_cvt_pk_bf16_f32 v151, v130, v131
    s_nop 0
    v_permlane32_swap_b32 v148, v150
    v_permlane32_swap_b32 v149, v151
    buffer_store_dwordx4 v[148:151], v9, s[48:51], s62 offen offset:1024 sc1
    s_waitcnt vmcnt(0)
    s_barrier
    s_endpgm
K1_KV:
    s_sub_u32 s26, s26, 22
    v_and_b32 v14, 15, v0
    v_lshrrev_b32 v15, 4, v0
    v_bfe_u32 v9, v0, 1, 3
    v_xor_b32 v9, v9, v15
    s_lshl_b32 s61, s60, 13
    v_lshl_add_u32 v10, v14, 7, s61
    v_lshl_add_u32 v2, v9, 4, v10
    v_xor_b32 v9, 4, v9
    v_lshl_add_u32 v3, v9, 4, v10
    v_bfe_u32 v9, v0, 2, 2
    v_lshl_add_u32 v9, v15, 3, v9
    v_mul_u32_u24 v9, 320, v9
    v_and_b32 v10, 3, v0
    v_lshl_add_u32 v9, v10, 3, v9
    v_bfe_u32 v10, v0, 4, 1
    v_lshlrev_b32 v10, 5, v10
    s_mul_i32 s62, s67, 96
    v_add_u32 v9, s62, v9
    v_add_u32 v11, v9, v10
    v_sub_u32 v12, v9, v10
    s_cmp_eq_u32 s67, 0
    s_cselect_b64 s[68:69], -1, 0
    v_cndmask_b32 v4, v12, v11, s[68:69]
    v_cndmask_b32 v5, v11, v12, s[68:69]
    s_lshl_b32 s70, s67, 6
    v_mov_b32 v16, 0
    v_mov_b32 v17, 0
    v_mov_b32 v18, 0
    v_mov_b32 v19, 0
    v_mov_b32 v20, 0
    v_mov_b32 v21, 0
    v_mov_b32 v22, 0
    v_mov_b32 v23, 0
    v_mov_b32 v24, 0
    v_mov_b32 v25, 0
    v_mov_b32 v26, 0
    v_mov_b32 v27, 0
    v_mov_b32 v28, 0
    v_mov_b32 v29, 0
    v_mov_b32 v30, 0
    v_mov_b32 v31, 0
    v_mov_b32 v32, 0
    v_mov_b32 v33, 0
    v_mov_b32 v34, 0
    v_mov_b32 v35, 0
    v_mov_b32 v36, 0
    v_mov_b32 v37, 0
    v_mov_b32 v38, 0
    v_mov_b32 v39, 0
    v_mov_b32 v40, 0
    v_mov_b32 v41, 0
    v_mov_b32 v42, 0
    v_mov_b32 v43, 0
    v_mov_b32 v44, 0
    v_mov_b32 v45, 0
    v_mov_b32 v46, 0
    v_mov_b32 v47, 0
    v_mov_b32 v48, 0
    v_mov_b32 v49, 0
    v_mov_b32 v50, 0
    v_mov_b32 v51, 0
    v_mov_b32 v52, 0
    v_mov_b32 v53, 0
    v_mov_b32 v54, 0
    v_mov_b32 v55, 0
    v_mov_b32 v56, 0
    v_mov_b32 v57, 0
    v_mov_b32 v58, 0
    v_mov_b32 v59, 0
    v_mov_b32 v60, 0
    v_mov_b32 v61, 0
    v_mov_b32 v62, 0
    v_mov_b32 v63, 0
    v_mov_b32 v64, 0
    v_mov_b32 v65, 0
    v_mov_b32 v66, 0
    v_mov_b32 v67, 0
    v_mov_b32 v68, 0
    v_mov_b32 v69, 0
    v_mov_b32 v70, 0
    v_mov_b32 v71, 0
    v_mov_b32 v72, 0
    v_mov_b32 v73, 0
    v_mov_b32 v74, 0
    v_mov_b32 v75, 0
    v_mov_b32 v76, 0
    v_mov_b32 v77, 0
    v_mov_b32 v78, 0
    v_mov_b32 v79, 0
    v_mov_b32 v80, 0
    v_mov_b32 v81, 0
    v_mov_b32 v82, 0
    v_mov_b32 v83, 0
    v_mov_b32 v84, 0
    v_mov_b32 v85, 0
    v_mov_b32 v86, 0
    v_mov_b32 v87, 0
    v_mov_b32 v88, 0
    v_mov_b32 v89, 0
    v_mov_b32 v90, 0
    v_mov_b32 v91, 0
    v_mov_b32 v92, 0
    v_mov_b32 v93, 0
    v_mov_b32 v94, 0
    v_mov_b32 v95, 0
    s_mov_b32 s63, 0
    s_mov_b32 s64, 32768
    s_mov_b32 s65, 98304
    s_mov_b32 s66, 0
    s_cmp_eq_u32 s67, 0
    s_cselect_b32 s71, 8, 99
    v_add_u32 v7, s65, v4
    v_add_u32 v8, s65, v5
    v_add_u32 v13, s70, v7
    s_barrier
    v_add_u32 v6, s63, v2
    ds_read_b64_tr_b16 v[144:145], v7 offset:0
    ds_read_b64_tr_b16 v[146:147], v7 offset:1280
    ds_read_b128 v[112:115], v6 offset:0
    ds_read_b128 v[116:119], v6 offset:2048
    ds_read_b128 v[120:123], v6 offset:4096
    ds_read_b128 v[124:127], v6 offset:6144
    ds_read_b64_tr_b16 v[148:149], v8 offset:32
    ds_read_b64_tr_b16 v[150:151], v8 offset:1312
    ds_read_b64_tr_b16 v[152:153], v13 offset:64
    ds_read_b64_tr_b16 v[154:155], v13 offset:1344
K1_LOOP_K:
    s_waitcnt lgkmcnt(0)
    v_mfma_f32_16x16x32_bf16 v[16:19], v[112:115], v[144:147], v[16:19]
    v_mfma_f32_16x16x32_bf16 v[20:23], v[116:119], v[144:147], v[20:23]
    ds_read_b64_tr_b16 v[156:157], v8 offset:160
    v_mfma_f32_16x16x32_bf16 v[24:27], v[120:123], v[144:147], v[24:27]
    ds_read_b64_tr_b16 v[158:159], v8 offset:1440
    v_mfma_f32_16x16x32_bf16 v[28:31], v[124:127], v[144:147], v[28:31]
    ds_read_b64_tr_b16 v[160:161], v7 offset:192
    v_mfma_f32_16x16x32_bf16 v[32:35], v[112:115], v[148:151], v[32:35]
    ds_read_b64_tr_b16 v[162:163], v7 offset:1472
    v_mfma_f32_16x16x32_bf16 v[36:39], v[116:119], v[148:151], v[36:39]
    v_mfma_f32_16x16x32_bf16 v[40:43], v[120:123], v[148:151], v[40:43]
    v_mfma_f32_16x16x32_bf16 v[44:47], v[124:127], v[148:151], v[44:47]
    v_mfma_f32_16x16x32_bf16 v[48:51], v[112:115], v[152:155], v[48:51]
    v_mfma_f32_16x16x32_bf16 v[52:55], v[116:119], v[152:155], v[52:55]
    v_mfma_f32_16x16x32_bf16 v[56:59], v[120:123], v[152:155], v[56:59]
    v_mfma_f32_16x16x32_bf16 v[60:63], v[124:127], v[152:155], v[60:63]
    s_waitcnt lgkmcnt(0)
    v_mfma_f32_16x16x32_bf16 v[64:67], v[112:115], v[156:159], v[64:67]
    v_mfma_f32_16x16x32_bf16 v[68:71], v[116:119], v[156:159], v[68:71]
    s_barrier
    s_add_u32 s65, s65, 12288
    s_cmp_ge_u32 s65, 159744
    v_mfma_f32_16x16x32_bf16 v[72:75], v[120:123], v[156:159], v[72:75]
    s_cselect_b32 s65, 98304, s65
    v_add_u32 v7, s65, v4
    v_mfma_f32_16x16x32_bf16 v[76:79], v[124:127], v[156:159], v[76:79]
    v_add_u32 v8, s65, v5
    v_add_u32 v13, s70, v7
    v_mfma_f32_16x16x32_bf16 v[80:83], v[112:115], v[160:163], v[80:83]
    v_add_u32 v6, s63, v3
    ds_read_b64_tr_b16 v[144:145], v7 offset:0
    v_mfma_f32_16x16x32_bf16 v[84:87], v[116:119], v[160:163], v[84:87]
    ds_read_b64_tr_b16 v[146:147], v7 offset:1280
    ds_read_b128 v[128:131], v6 offset:0
    v_mfma_f32_16x16x32_bf16 v[88:91], v[120:123], v[160:163], v[88:91]
    ds_read_b128 v[132:135], v6 offset:2048
    ds_read_b128 v[136:139], v6 offset:4096
    v_mfma_f32_16x16x32_bf16 v[92:95], v[124:127], v[160:163], v[92:95]
    ds_read_b128 v[140:143], v6 offset:6144
    ds_read_b64_tr_b16 v[148:149], v8 offset:32
    ds_read_b64_tr_b16 v[150:151], v8 offset:1312
    ds_read_b64_tr_b16 v[152:153], v13 offset:64
    ds_read_b64_tr_b16 v[154:155], v13 offset:1344
    s_waitcnt lgkmcnt(0)
    v_mfma_f32_16x16x32_bf16 v[16:19], v[128:131], v[144:147], v[16:19]
    v_mfma_f32_16x16x32_bf16 v[20:23], v[132:135], v[144:147], v[20:23]
    ds_read_b64_tr_b16 v[156:157], v8 offset:160
    v_mfma_f32_16x16x32_bf16 v[24:27], v[136:139], v[144:147], v[24:27]
    ds_read_b64_tr_b16 v[158:159], v8 offset:1440
    v_mfma_f32_16x16x32_bf16 v[28:31], v[140:143], v[144:147], v[28:31]
    ds_read_b64_tr_b16 v[160:161], v7 offset:192
    v_mfma_f32_16x16x32_bf16 v[32:35], v[128:131], v[148:151], v[32:35]
    ds_read_b64_tr_b16 v[162:163], v7 offset:1472
    v_mfma_f32_16x16x32_bf16 v[36:39], v[132:135], v[148:151], v[36:39]
    v_mfma_f32_16x16x32_bf16 v[40:43], v[136:139], v[148:151], v[40:43]
    v_mfma_f32_16x16x32_bf16 v[44:47], v[140:143], v[148:151], v[44:47]
    v_mfma_f32_16x16x32_bf16 v[48:51], v[128:131], v[152:155], v[48:51]
    v_mfma_f32_16x16x32_bf16 v[52:55], v[132:135], v[152:155], v[52:55]
    v_mfma_f32_16x16x32_bf16 v[56:59], v[136:139], v[152:155], v[56:59]
    v_mfma_f32_16x16x32_bf16 v[60:63], v[140:143], v[152:155], v[60:63]
    s_waitcnt lgkmcnt(0)
    v_mfma_f32_16x16x32_bf16 v[64:67], v[128:131], v[156:159], v[64:67]
    v_mfma_f32_16x16x32_bf16 v[68:71], v[132:135], v[156:159], v[68:71]
    s_barrier
    s_add_u32 s65, s65, 12288
    s_cmp_ge_u32 s65, 159744
    v_mfma_f32_16x16x32_bf16 v[72:75], v[136:139], v[156:159], v[72:75]
    s_cselect_b32 s65, 98304, s65
    v_add_u32 v7, s65, v4
    v_mfma_f32_16x16x32_bf16 v[76:79], v[140:143], v[156:159], v[76:79]
    v_add_u32 v8, s65, v5
    v_add_u32 v13, s70, v7
    v_mfma_f32_16x16x32_bf16 v[80:83], v[128:131], v[160:163], v[80:83]
    v_add_u32 v6, s64, v2
    ds_read_b64_tr_b16 v[144:145], v7 offset:0
    v_mfma_f32_16x16x32_bf16 v[84:87], v[132:135], v[160:163], v[84:87]
    ds_read_b64_tr_b16 v[146:147], v7 offset:1280
    ds_read_b128 v[112:115], v6 offset:0
    v_mfma_f32_16x16x32_bf16 v[88:91], v[136:139], v[160:163], v[88:91]
    ds_read_b128 v[116:119], v6 offset:2048
    ds_read_b128 v[120:123], v6 offset:4096
    v_mfma_f32_16x16x32_bf16 v[92:95], v[140:143], v[160:163], v[92:95]
    ds_read_b128 v[124:127], v6 offset:6144
    ds_read_b64_tr_b16 v[148:149], v8 offset:32
    ds_read_b64_tr_b16 v[150:151], v8 offset:1312
    ds_read_b64_tr_b16 v[152:153], v13 offset:64
    ds_read_b64_tr_b16 v[154:155], v13 offset:1344
    s_mov_b32 s63, s64
    s_add_u32 s64, s64, 32768
    s_cmp_ge_u32 s64, 98304
    s_cselect_b32 s64, 0, s64
    s_add_u32 s66, s66, 1
    s_cmp_lt_u32 s66, 10
    s_cbranch_scc1 K1_LOOP_K
    s_waitcnt lgkmcnt(0)
    s_lshl_b32 s61, s60, 8
    s_add_u32 s61, s61, 159744
    v_lshl_add_u32 v9, v0, 2, s61
    ds_read_b32 v152, v9
    v_lshlrev_b32 v10, 2, v14
    s_mul_i32 s62, s67, 192
    s_add_u32 s62, s62, 161792
    v_add_u32 v10, s62, v10
    s_lshl_b32 s70, s67, 7
    v_add_u32 v11, s70, v10
    ds_read_b32 v128, v10 offset:0
    ds_read_b32 v132, v10 offset:64
    ds_read_b32 v136, v11 offset:128
    ds_read_b32 v140, v10 offset:320
    ds_read_b32 v144, v10 offset:384
    v_mov_b32 v113, 0
    v_mov_b32 v117, 0
    v_mov_b32 v121, 0
    v_mov_b32 v125, 0
    v_mov_b32 v129, 0
    v_mov_b32 v133, 0
    v_mov_b32 v137, 0
    v_mov_b32 v141, 0
    v_mov_b32 v145, 0
    v_mov_b32 v114, 0
    v_mov_b32 v118, 0
    v_mov_b32 v122, 0
    v_mov_b32 v126, 0
    v_mov_b32 v130, 0
    v_mov_b32 v134, 0
    v_mov_b32 v138, 0
    v_mov_b32 v142, 0
    v_mov_b32 v146, 0
    v_mov_b32 v115, 0
    v_mov_b32 v119, 0
    v_mov_b32 v123, 0
    v_mov_b32 v127, 0
    v_mov_b32 v131, 0
    v_mov_b32 v135, 0
    v_mov_b32 v139, 0
    v_mov_b32 v143, 0
    v_mov_b32 v147, 0
    v_cmp_eq_u32 s[72:73], 0, v15
    v_cmp_eq_u32 s[74:75], 1, v15
    v_cmp_eq_u32 s[76:77], 2, v15
    v_cmp_eq_u32 s[78:79], 3, v15
    s_waitcnt lgkmcnt(0)
    v_cndmask_b32 v112, 0, v152, s[72:73]
    v_cndmask_b32 v116, 0, v152, s[74:75]
    v_cndmask_b32 v120, 0, v152, s[76:77]
    v_cndmask_b32 v124, 0, v152, s[78:79]
    v_mfma_f32_16x16x32_bf16 v[64:67], v[112:115], v[140:143], v[64:67]
    v_mfma_f32_16x16x32_bf16 v[68:71], v[116:119], v[140:143], v[68:71]
    v_mfma_f32_16x16x32_bf16 v[72:75], v[120:123], v[140:143], v[72:75]
    v_mfma_f32_16x16x32_bf16 v[76:79], v[124:127], v[140:143], v[76:79]
    v_mfma_f32_16x16x32_bf16 v[80:83], v[112:115], v[144:147], v[80:83]
    v_mfma_f32_16x16x32_bf16 v[84:87], v[116:119], v[144:147], v[84:87]
    v_mfma_f32_16x16x32_bf16 v[88:91], v[120:123], v[144:147], v[88:91]
    v_mfma_f32_16x16x32_bf16 v[92:95], v[124:127], v[144:147], v[92:95]
    v_mfma_f32_16x16x32_bf16 v[16:19], v[112:115], v[128:131], v[16:19]
    v_mfma_f32_16x16x32_bf16 v[20:23], v[116:119], v[128:131], v[20:23]
    v_mfma_f32_16x16x32_bf16 v[24:27], v[120:123], v[128:131], v[24:27]
    v_mfma_f32_16x16x32_bf16 v[28:31], v[124:127], v[128:131], v[28:31]
    v_mfma_f32_16x16x32_bf16 v[32:35], v[112:115], v[132:135], v[32:35]
    v_mfma_f32_16x16x32_bf16 v[36:39], v[116:119], v[132:135], v[36:39]
    v_mfma_f32_16x16x32_bf16 v[40:43], v[120:123], v[132:135], v[40:43]
    v_mfma_f32_16x16x32_bf16 v[44:47], v[124:127], v[132:135], v[44:47]
    v_mfma_f32_16x16x32_bf16 v[48:51], v[112:115], v[136:139], v[48:51]
    v_mfma_f32_16x16x32_bf16 v[52:55], v[116:119], v[136:139], v[52:55]
    v_mfma_f32_16x16x32_bf16 v[56:59], v[120:123], v[136:139], v[56:59]
    v_mfma_f32_16x16x32_bf16 v[60:63], v[124:127], v[136:139], v[60:63]
    v_lshl_add_u32 v9, v15, 4, s61
    ds_read_b128 v[152:155], v9 offset:1024
    ds_read_b128 v[156:159], v9 offset:1088
    ds_read_b128 v[160:163], v9 offset:1152
    ds_read_b128 v[164:167], v9 offset:1216
    s_lshl_b32 s61, s60, 11
    s_mul_i32 s62, s67, 24576
    s_add_u32 s61, s61, s62
    v_lshl_add_u32 v10, v0, 4, s61
    s_lshl_b32 s62, s67, 14
    v_add_u32 v11, s62, v10
    s_mov_b32 s64, 0x358637bd
    s_mov_b32 s65, 0x358637bd
    s_mov_b32 s62, 0x3fb8aa3b
    s_mov_b32 s63, 0x3fb8aa3b
    s_cmp_eq_u32 s67, 0
    s_cselect_b64 s[68:69], -1, 0
    s_waitcnt lgkmcnt(0)
    v_pk_mul_f32 v[128:129], v[64:65], v[152:153]
    v_pk_mul_f32 v[130:131], v[66:67], v[154:155]
    v_cvt_pk_bf16_f32 v112, v128, v129
    v_cvt_pk_bf16_f32 v113, v130, v131
    v_pk_mul_f32 v[128:129], v[68:69], v[156:157]
    v_pk_mul_f32 v[130:131], v[70:71], v[158:159]
    v_cvt_pk_bf16_f32 v114, v128, v129
    v_cvt_pk_bf16_f32 v115, v130, v131
    ds_write_b128 v10, v[112:115] offset:40960
    v_pk_mul_f32 v[128:129], v[72:73], v[160:161]
    v_pk_mul_f32 v[130:131], v[74:75], v[162:163]
    v_cvt_pk_bf16_f32 v116, v128, v129
    v_cvt_pk_bf16_f32 v117, v130, v131
    v_pk_mul_f32 v[128:129], v[76:77], v[164:165]
    v_pk_mul_f32 v[130:131], v[78:79], v[166:167]
    v_cvt_pk_bf16_f32 v118, v128, v129
    v_cvt_pk_bf16_f32 v119, v130, v131
    ds_write_b128 v10, v[116:119] offset:41984
    v_pk_mul_f32 v[128:129], v[80:81], v[152:153]
    v_pk_mul_f32 v[130:131], v[82:83], v[154:155]
    v_cvt_pk_bf16_f32 v120, v128, v129
    v_cvt_pk_bf16_f32 v121, v130, v131
    v_pk_mul_f32 v[128:129], v[84:85], v[156:157]
    v_pk_mul_f32 v[130:131], v[86:87], v[158:159]
    v_cvt_pk_bf16_f32 v122, v128, v129
    v_cvt_pk_bf16_f32 v123, v130, v131
    ds_write_b128 v10, v[120:123] offset:49152
    v_pk_mul_f32 v[128:129], v[88:89], v[160:161]
    v_pk_mul_f32 v[130:131], v[90:91], v[162:163]
    v_cvt_pk_bf16_f32 v124, v128, v129
    v_cvt_pk_bf16_f32 v125, v130, v131
    v_pk_mul_f32 v[128:129], v[92:93], v[164:165]
    v_pk_mul_f32 v[130:131], v[94:95], v[166:167]
    v_cvt_pk_bf16_f32 v126, v128, v129
    v_cvt_pk_bf16_f32 v127, v130, v131
    ds_write_b128 v10, v[124:127] offset:50176
    v_pk_mul_f32 v[136:137], v[16:17], v[152:153]
    v_pk_mul_f32 v[138:139], v[18:19], v[154:155]
    v_pk_mul_f32 v[128:129], v[136:137], s[62:63]
    v_pk_mul_f32 v[130:131], v[138:139], s[62:63]
    v_pk_add_f32 v[132:133], v[136:137], s[64:65]
    v_pk_add_f32 v[134:135], v[138:139], s[64:65]
    v_exp_f32 v128, v128 clamp
    v_exp_f32 v129, v129 clamp
    v_exp_f32 v130, v130 clamp
    v_exp_f32 v131, v131 clamp
    v_max_f32 v132, s64, v132
    v_max_f32 v133, s64, v133
    v_max_f32 v134, s64, v134
    v_max_f32 v135, s64, v135
    v_pk_add_f32 v[128:129], v[128:129], v[132:133]
    v_pk_add_f32 v[130:131], v[130:131], v[134:135]
    v_cvt_pk_bf16_f32 v112, v128, v129
    v_cvt_pk_bf16_f32 v113, v130, v131
    v_pk_mul_f32 v[136:137], v[20:21], v[156:157]
    v_pk_mul_f32 v[138:139], v[22:23], v[158:159]
    v_pk_mul_f32 v[128:129], v[136:137], s[62:63]
    v_pk_mul_f32 v[130:131], v[138:139], s[62:63]
    v_pk_add_f32 v[132:133], v[136:137], s[64:65]
    v_pk_add_f32 v[134:135], v[138:139], s[64:65]
    v_exp_f32 v128, v128 clamp
    v_exp_f32 v129, v129 clamp
    v_exp_f32 v130, v130 clamp
    v_exp_f32 v131, v131 clamp
    v_max_f32 v132, s64, v132
    v_max_f32 v133, s64, v133
    v_max_f32 v134, s64, v134
    v_max_f32 v135, s64, v135
    v_pk_add_f32 v[128:129], v[128:129], v[132:133]
    v_pk_add_f32 v[130:131], v[130:131], v[134:135]
    v_cvt_pk_bf16_f32 v114, v128, v129
    v_cvt_pk_bf16_f32 v115, v130, v131
    ds_write_b128 v10, v[112:115] offset:0
    v_pk_mul_f32 v[136:137], v[24:25], v[160:161]
    v_pk_mul_f32 v[138:139], v[26:27], v[162:163]
    v_pk_mul_f32 v[128:129], v[136:137], s[62:63]
    v_pk_mul_f32 v[130:131], v[138:139], s[62:63]
    v_pk_add_f32 v[132:133], v[136:137], s[64:65]
    v_pk_add_f32 v[134:135], v[138:139], s[64:65]
    v_exp_f32 v128, v128 clamp
    v_exp_f32 v129, v129 clamp
    v_exp_f32 v130, v130 clamp
    v_exp_f32 v131, v131 clamp
    v_max_f32 v132, s64, v132
    v_max_f32 v133, s64, v133
    v_max_f32 v134, s64, v134
    v_max_f32 v135, s64, v135
    v_pk_add_f32 v[128:129], v[128:129], v[132:133]
    v_pk_add_f32 v[130:131], v[130:131], v[134:135]
    v_cvt_pk_bf16_f32 v116, v128, v129
    v_cvt_pk_bf16_f32 v117, v130, v131
    v_pk_mul_f32 v[136:137], v[28:29], v[164:165]
    v_pk_mul_f32 v[138:139], v[30:31], v[166:167]
    v_pk_mul_f32 v[128:129], v[136:137], s[62:63]
    v_pk_mul_f32 v[130:131], v[138:139], s[62:63]
    v_pk_add_f32 v[132:133], v[136:137], s[64:65]
    v_pk_add_f32 v[134:135], v[138:139], s[64:65]
    v_exp_f32 v128, v128 clamp
    v_exp_f32 v129, v129 clamp
    v_exp_f32 v130, v130 clamp
    v_exp_f32 v131, v131 clamp
    v_max_f32 v132, s64, v132
    v_max_f32 v133, s64, v133
    v_max_f32 v134, s64, v134
    v_max_f32 v135, s64, v135
    v_pk_add_f32 v[128:129], v[128:129], v[132:133]
    v_pk_add_f32 v[130:131], v[130:131], v[134:135]
    v_cvt_pk_bf16_f32 v118, v128, v129
    v_cvt_pk_bf16_f32 v119, v130, v131
    ds_write_b128 v10, v[116:119] offset:1024
    v_pk_mul_f32 v[136:137], v[32:33], v[152:153]
    v_pk_mul_f32 v[138:139], v[34:35], v[154:155]
    v_pk_mul_f32 v[128:129], v[136:137], s[62:63]
    v_pk_mul_f32 v[130:131], v[138:139], s[62:63]
    v_pk_add_f32 v[132:133], v[136:137], s[64:65]
    v_pk_add_f32 v[134:135], v[138:139], s[64:65]
    v_exp_f32 v128, v128 clamp
    v_exp_f32 v129, v129 clamp
    v_exp_f32 v130, v130 clamp
    v_exp_f32 v131, v131 clamp
    v_max_f32 v132, s64, v132
    v_max_f32 v133, s64, v133
    v_max_f32 v134, s64, v134
    v_max_f32 v135, s64, v135
    v_pk_add_f32 v[128:129], v[128:129], v[132:133]
    v_pk_add_f32 v[130:131], v[130:131], v[134:135]
    v_cvt_pk_bf16_f32 v120, v128, v129
    v_cvt_pk_bf16_f32 v121, v130, v131
    v_pk_mul_f32 v[136:137], v[36:37], v[156:157]
    v_pk_mul_f32 v[138:139], v[38:39], v[158:159]
    v_pk_mul_f32 v[128:129], v[136:137], s[62:63]
    v_pk_mul_f32 v[130:131], v[138:139], s[62:63]
    v_pk_add_f32 v[132:133], v[136:137], s[64:65]
    v_pk_add_f32 v[134:135], v[138:139], s[64:65]
    v_exp_f32 v128, v128 clamp
    v_exp_f32 v129, v129 clamp
    v_exp_f32 v130, v130 clamp
    v_exp_f32 v131, v131 clamp
    v_max_f32 v132, s64, v132
    v_max_f32 v133, s64, v133
    v_max_f32 v134, s64, v134
    v_max_f32 v135, s64, v135
    v_pk_add_f32 v[128:129], v[128:129], v[132:133]
    v_pk_add_f32 v[130:131], v[130:131], v[134:135]
    v_cvt_pk_bf16_f32 v122, v128, v129
    v_cvt_pk_bf16_f32 v123, v130, v131
    ds_write_b128 v10, v[120:123] offset:8192
    v_pk_mul_f32 v[136:137], v[40:41], v[160:161]
    v_pk_mul_f32 v[138:139], v[42:43], v[162:163]
    v_pk_mul_f32 v[128:129], v[136:137], s[62:63]
    v_pk_mul_f32 v[130:131], v[138:139], s[62:63]
    v_pk_add_f32 v[132:133], v[136:137], s[64:65]
    v_pk_add_f32 v[134:135], v[138:139], s[64:65]
    v_exp_f32 v128, v128 clamp
    v_exp_f32 v129, v129 clamp
    v_exp_f32 v130, v130 clamp
    v_exp_f32 v131, v131 clamp
    v_max_f32 v132, s64, v132
    v_max_f32 v133, s64, v133
    v_max_f32 v134, s64, v134
    v_max_f32 v135, s64, v135
    v_pk_add_f32 v[128:129], v[128:129], v[132:133]
    v_pk_add_f32 v[130:131], v[130:131], v[134:135]
    v_cvt_pk_bf16_f32 v124, v128, v129
    v_cvt_pk_bf16_f32 v125, v130, v131
    v_pk_mul_f32 v[136:137], v[44:45], v[164:165]
    v_pk_mul_f32 v[138:139], v[46:47], v[166:167]
    v_pk_mul_f32 v[128:129], v[136:137], s[62:63]
    v_pk_mul_f32 v[130:131], v[138:139], s[62:63]
    v_pk_add_f32 v[132:133], v[136:137], s[64:65]
    v_pk_add_f32 v[134:135], v[138:139], s[64:65]
    v_exp_f32 v128, v128 clamp
    v_exp_f32 v129, v129 clamp
    v_exp_f32 v130, v130 clamp
    v_exp_f32 v131, v131 clamp
    v_max_f32 v132, s64, v132
    v_max_f32 v133, s64, v133
    v_max_f32 v134, s64, v134
    v_max_f32 v135, s64, v135
    v_pk_add_f32 v[128:129], v[128:129], v[132:133]
    v_pk_add_f32 v[130:131], v[130:131], v[134:135]
    v_cvt_pk_bf16_f32 v126, v128, v129
    v_cvt_pk_bf16_f32 v127, v130, v131
    ds_write_b128 v10, v[124:127] offset:9216
    s_cmp_lg_u32 s67, 0
    s_cbranch_scc1 K1_KV_T2V
    v_pk_mul_f32 v[136:137], v[48:49], v[152:153]
    v_pk_mul_f32 v[138:139], v[50:51], v[154:155]
    v_pk_mul_f32 v[128:129], v[136:137], s[62:63]
    v_pk_mul_f32 v[130:131], v[138:139], s[62:63]
    v_pk_add_f32 v[132:133], v[136:137], s[64:65]
    v_pk_add_f32 v[134:135], v[138:139], s[64:65]
    v_exp_f32 v128, v128 clamp
    v_exp_f32 v129, v129 clamp
    v_exp_f32 v130, v130 clamp
    v_exp_f32 v131, v131 clamp
    v_max_f32 v132, s64, v132
    v_max_f32 v133, s64, v133
    v_max_f32 v134, s64, v134
    v_max_f32 v135, s64, v135
    v_pk_add_f32 v[128:129], v[128:129], v[132:133]
    v_pk_add_f32 v[130:131], v[130:131], v[134:135]
    v_cvt_pk_bf16_f32 v112, v128, v129
    v_cvt_pk_bf16_f32 v113, v130, v131
    v_pk_mul_f32 v[136:137], v[52:53], v[156:157]
    v_pk_mul_f32 v[138:139], v[54:55], v[158:159]
    v_pk_mul_f32 v[128:129], v[136:137], s[62:63]
    v_pk_mul_f32 v[130:131], v[138:139], s[62:63]
    v_pk_add_f32 v[132:133], v[136:137], s[64:65]
    v_pk_add_f32 v[134:135], v[138:139], s[64:65]
    v_exp_f32 v128, v128 clamp
    v_exp_f32 v129, v129 clamp
    v_exp_f32 v130, v130 clamp
    v_exp_f32 v131, v131 clamp
    v_max_f32 v132, s64, v132
    v_max_f32 v133, s64, v133
    v_max_f32 v134, s64, v134
    v_max_f32 v135, s64, v135
    v_pk_add_f32 v[128:129], v[128:129], v[132:133]
    v_pk_add_f32 v[130:131], v[130:131], v[134:135]
    v_cvt_pk_bf16_f32 v114, v128, v129
    v_cvt_pk_bf16_f32 v115, v130, v131
    ds_write_b128 v11, v[112:115] offset:16384
    v_pk_mul_f32 v[136:137], v[56:57], v[160:161]
    v_pk_mul_f32 v[138:139], v[58:59], v[162:163]
    v_pk_mul_f32 v[128:129], v[136:137], s[62:63]
    v_pk_mul_f32 v[130:131], v[138:139], s[62:63]
    v_pk_add_f32 v[132:133], v[136:137], s[64:65]
    v_pk_add_f32 v[134:135], v[138:139], s[64:65]
    v_exp_f32 v128, v128 clamp
    v_exp_f32 v129, v129 clamp
    v_exp_f32 v130, v130 clamp
    v_exp_f32 v131, v131 clamp
    v_max_f32 v132, s64, v132
    v_max_f32 v133, s64, v133
    v_max_f32 v134, s64, v134
    v_max_f32 v135, s64, v135
    v_pk_add_f32 v[128:129], v[128:129], v[132:133]
    v_pk_add_f32 v[130:131], v[130:131], v[134:135]
    v_cvt_pk_bf16_f32 v116, v128, v129
    v_cvt_pk_bf16_f32 v117, v130, v131
    v_pk_mul_f32 v[136:137], v[60:61], v[164:165]
    v_pk_mul_f32 v[138:139], v[62:63], v[166:167]
    v_pk_mul_f32 v[128:129], v[136:137], s[62:63]
    v_pk_mul_f32 v[130:131], v[138:139], s[62:63]
    v_pk_add_f32 v[132:133], v[136:137], s[64:65]
    v_pk_add_f32 v[134:135], v[138:139], s[64:65]
    v_exp_f32 v128, v128 clamp
    v_exp_f32 v129, v129 clamp
    v_exp_f32 v130, v130 clamp
    v_exp_f32 v131, v131 clamp
    v_max_f32 v132, s64, v132
    v_max_f32 v133, s64, v133
    v_max_f32 v134, s64, v134
    v_max_f32 v135, s64, v135
    v_pk_add_f32 v[128:129], v[128:129], v[132:133]
    v_pk_add_f32 v[130:131], v[130:131], v[134:135]
    v_cvt_pk_bf16_f32 v118, v128, v129
    v_cvt_pk_bf16_f32 v119, v130, v131
    ds_write_b128 v11, v[116:119] offset:17408
    s_branch K1_KV_T2E
K1_KV_T2V:
    v_pk_mul_f32 v[128:129], v[48:49], v[152:153]
    v_pk_mul_f32 v[130:131], v[50:51], v[154:155]
    v_cvt_pk_bf16_f32 v120, v128, v129
    v_cvt_pk_bf16_f32 v121, v130, v131
    v_pk_mul_f32 v[128:129], v[52:53], v[156:157]
    v_pk_mul_f32 v[130:131], v[54:55], v[158:159]
    v_cvt_pk_bf16_f32 v122, v128, v129
    v_cvt_pk_bf16_f32 v123, v130, v131
    ds_write_b128 v11, v[120:123] offset:16384
    v_pk_mul_f32 v[128:129], v[56:57], v[160:161]
    v_pk_mul_f32 v[130:131], v[58:59], v[162:163]
    v_cvt_pk_bf16_f32 v124, v128, v129
    v_cvt_pk_bf16_f32 v125, v130, v131
    v_pk_mul_f32 v[128:129], v[60:61], v[164:165]
    v_pk_mul_f32 v[130:131], v[62:63], v[166:167]
    v_cvt_pk_bf16_f32 v126, v128, v129
    v_cvt_pk_bf16_f32 v127, v130, v131
    ds_write_b128 v11, v[124:127] offset:17408
K1_KV_T2E:
    s_waitcnt lgkmcnt(0)
    s_barrier
    v_lshlrev_b32 v2, 4, v0
    s_sub_u32 s61, s24, 5
    s_add_u32 s62, s61, 1
    s_cmp_lt_u32 s24, 5
    s_cselect_b32 s63, s24, s61
    s_cselect_b32 s64, s24, s62
    s_cselect_b32 s65, s24, s62
    s_cselect_b32 s66, s24, s61
    s_cselect_b32 s70, 1, 0
    s_add_u32 s71, s24, 3
    s_sub_u32 s72, 4, s24
    s_lshl_b32 s74, s25, 6
    s_lshl_b32 s75, s26, 3
    s_add_u32 s74, s74, s75
    s_lshl_b32 s74, s74, 11
    s_add_u32 s74, s74, 12730368
    v_mov_b32 v13, 1073741824
    s_lshl_b32 s76, s63, 13
    v_add_u32 v3, s76, v2
    s_lshl_b32 s77, s64, 13
    s_add_u32 s77, s77, 40960
    v_add_u32 v4, s77, v2
    ds_read_b128 v[16:19], v3 offset:0
    ds_read_b128 v[20:23], v3 offset:1024
    ds_read_b128 v[24:27], v3 offset:2048
    ds_read_b128 v[28:31], v3 offset:3072
    ds_read_b128 v[32:35], v3 offset:4096
    ds_read_b128 v[36:39], v3 offset:5120
    ds_read_b128 v[40:43], v3 offset:6144
    ds_read_b128 v[44:47], v3 offset:7168
    ds_read_b128 v[48:51], v4 offset:0
    ds_read_b128 v[52:55], v4 offset:1024
    ds_read_b128 v[56:59], v4 offset:2048
    ds_read_b128 v[60:63], v4 offset:3072
    ds_read_b128 v[64:67], v4 offset:4096
    ds_read_b128 v[68:71], v4 offset:5120
    ds_read_b128 v[72:75], v4 offset:6144
    ds_read_b128 v[76:79], v4 offset:7168
    s_lshl_b32 s77, s64, 4
    v_add_u32 v6, s77, v14
    v_mul_u32_u24 v7, 3277, v6
    v_lshrrev_b32 v7, 16, v7
    v_mul_u32_u24 v8, 20, v7
    v_sub_u32 v8, v6, v8
    v_cmp_le_u32 vcc, 10, v8
    s_nop 1
    v_cndmask_b32 v9, 0, 1, vcc
    v_mul_u32_u24 v10, 10, v9
    v_sub_u32 v10, v8, v10
    v_lshrrev_b32 v11, 2, v10
    v_lshlrev_b32 v11, 3, v11
    v_lshl_add_u32 v11, v9, 2, v11
    v_and_b32 v12, 3, v10
    v_add_u32 v11, v11, v12
    v_sub_u32 v12, s63, v7
    v_cmp_gt_u32 vcc, 2, v12
    v_lshl_add_u32 v12, v7, 1, v12
    v_lshl_add_u32 v11, v12, 6, v11
    v_and_b32 v12, 1, v15
    v_lshl_add_u32 v11, v12, 5, v11
    v_lshlrev_b32 v11, 5, v11
    v_lshrrev_b32 v12, 1, v15
    v_lshl_add_u32 v11, v12, 4, v11
    v_cndmask_b32 v11, v13, v11, vcc
    s_waitcnt lgkmcnt(0)
    v_mfma_f32_16x16x32_bf16 v[80:83], v[16:19], v[48:51], 0
    v_mfma_f32_16x16x32_bf16 v[80:83], v[20:23], v[52:55], v[80:83]
    v_mfma_f32_16x16x32_bf16 v[80:83], v[24:27], v[56:59], v[80:83]
    v_mfma_f32_16x16x32_bf16 v[80:83], v[28:31], v[60:63], v[80:83]
    v_mfma_f32_16x16x32_bf16 v[80:83], v[32:35], v[64:67], v[80:83]
    v_mfma_f32_16x16x32_bf16 v[80:83], v[36:39], v[68:71], v[80:83]
    v_mfma_f32_16x16x32_bf16 v[80:83], v[40:43], v[72:75], v[80:83]
    v_mfma_f32_16x16x32_bf16 v[80:83], v[44:47], v[76:79], v[80:83]
    s_nop 7
    buffer_store_dwordx4 v[80:83], v11, s[48:51], s74 offen sc1
    s_nop 1
    s_lshl_b32 s76, s65, 13
    v_add_u32 v3, s76, v2
    s_lshl_b32 s77, s66, 13
    s_add_u32 s77, s77, 40960
    v_add_u32 v4, s77, v2
    ds_read_b128 v[16:19], v3 offset:0
    ds_read_b128 v[20:23], v3 offset:1024
    ds_read_b128 v[24:27], v3 offset:2048
    ds_read_b128 v[28:31], v3 offset:3072
    ds_read_b128 v[32:35], v3 offset:4096
    ds_read_b128 v[36:39], v3 offset:5120
    ds_read_b128 v[40:43], v3 offset:6144
    ds_read_b128 v[44:47], v3 offset:7168
    ds_read_b128 v[48:51], v4 offset:0
    ds_read_b128 v[52:55], v4 offset:1024
    ds_read_b128 v[56:59], v4 offset:2048
    ds_read_b128 v[60:63], v4 offset:3072
    ds_read_b128 v[64:67], v4 offset:4096
    ds_read_b128 v[68:71], v4 offset:5120
    ds_read_b128 v[72:75], v4 offset:6144
    ds_read_b128 v[76:79], v4 offset:7168
    s_lshl_b32 s77, s66, 4
    v_add_u32 v6, s77, v14
    v_mul_u32_u24 v7, 3277, v6
    v_lshrrev_b32 v7, 16, v7
    v_mul_u32_u24 v8, 20, v7
    v_sub_u32 v8, v6, v8
    v_cmp_le_u32 vcc, 10, v8
    s_nop 1
    v_cndmask_b32 v9, 0, 1, vcc
    v_mul_u32_u24 v10, 10, v9
    v_sub_u32 v10, v8, v10
    v_lshrrev_b32 v11, 2, v10
    v_lshlrev_b32 v11, 3, v11
    v_lshl_add_u32 v11, v9, 2, v11
    v_and_b32 v12, 3, v10
    v_add_u32 v11, v11, v12
    s_cmp_eq_u32 s70, 0
    s_cbranch_scc1 K1_KVJ_NZ1
    s_waitcnt lgkmcnt(0)
    v_mov_b32 v48, 0x3f803f80
    v_mov_b32 v49, 0x3f803f80
    v_mov_b32 v50, 0x3f803f80
    v_mov_b32 v51, 0x3f803f80
    v_mov_b32 v52, 0x3f803f80
    v_mov_b32 v53, 0x3f803f80
    v_mov_b32 v54, 0x3f803f80
    v_mov_b32 v55, 0x3f803f80
    v_mov_b32 v56, 0x3f803f80
    v_mov_b32 v57, 0x3f803f80
    v_mov_b32 v58, 0x3f803f80
    v_mov_b32 v59, 0x3f803f80
    v_mov_b32 v60, 0x3f803f80
    v_mov_b32 v61, 0x3f803f80
    v_mov_b32 v62, 0x3f803f80
    v_mov_b32 v63, 0x3f803f80
    v_mov_b32 v64, 0x3f803f80
    v_mov_b32 v65, 0x3f803f80
    v_mov_b32 v66, 0x3f803f80
    v_mov_b32 v67, 0x3f803f80
    v_mov_b32 v68, 0x3f803f80
    v_mov_b32 v69, 0x3f803f80
    v_mov_b32 v70, 0x3f803f80
    v_mov_b32 v71, 0x3f803f80
    v_mov_b32 v72, 0x3f803f80
    v_mov_b32 v73, 0x3f803f80
    v_mov_b32 v74, 0x3f803f80
    v_mov_b32 v75, 0x3f803f80
    v_mov_b32 v76, 0x3f803f80
    v_mov_b32 v77, 0x3f803f80
    v_mov_b32 v78, 0x3f803f80
    v_mov_b32 v79, 0x3f803f80
    v_lshrrev_b32 v7, 1, v14
    v_and_b32 v11, 1, v14
    v_lshlrev_b32 v11, 2, v11
    v_add_u32 v11, 18, v11
    v_cmp_gt_u32 vcc, 8, v14
    s_nop 1
    v_cndmask_b32 v7, 64, v7, vcc
K1_KVJ_NZ1:
    v_sub_u32 v12, s65, v7
    v_cmp_gt_u32 vcc, 2, v12
    v_lshl_add_u32 v12, v7, 1, v12
    v_lshl_add_u32 v11, v12, 6, v11
    v_and_b32 v12, 1, v15
    v_lshl_add_u32 v11, v12, 5, v11
    v_lshlrev_b32 v11, 5, v11
    v_lshrrev_b32 v12, 1, v15
    v_lshl_add_u32 v11, v12, 4, v11
    v_cndmask_b32 v11, v13, v11, vcc
    s_waitcnt lgkmcnt(0)
    v_mfma_f32_16x16x32_bf16 v[80:83], v[16:19], v[48:51], 0
    v_mfma_f32_16x16x32_bf16 v[80:83], v[20:23], v[52:55], v[80:83]
    v_mfma_f32_16x16x32_bf16 v[80:83], v[24:27], v[56:59], v[80:83]
    v_mfma_f32_16x16x32_bf16 v[80:83], v[28:31], v[60:63], v[80:83]
    v_mfma_f32_16x16x32_bf16 v[80:83], v[32:35], v[64:67], v[80:83]
    v_mfma_f32_16x16x32_bf16 v[80:83], v[36:39], v[68:71], v[80:83]
    v_mfma_f32_16x16x32_bf16 v[80:83], v[40:43], v[72:75], v[80:83]
    v_mfma_f32_16x16x32_bf16 v[80:83], v[44:47], v[76:79], v[80:83]
    s_nop 7
    buffer_store_dwordx4 v[80:83], v11, s[48:51], s74 offen sc1
    s_nop 1
    s_cmp_ge_u32 s24, 2
    s_cbranch_scc1 K1_KVJ_DONE
    s_lshl_b32 s76, s71, 13
    v_add_u32 v3, s76, v2
    s_lshl_b32 s77, s72, 13
    s_add_u32 s77, s77, 40960
    v_add_u32 v4, s77, v2
    ds_read_b128 v[16:19], v3 offset:0
    ds_read_b128 v[20:23], v3 offset:1024
    ds_read_b128 v[24:27], v3 offset:2048
    ds_read_b128 v[28:31], v3 offset:3072
    ds_read_b128 v[32:35], v3 offset:4096
    ds_read_b128 v[36:39], v3 offset:5120
    ds_read_b128 v[40:43], v3 offset:6144
    ds_read_b128 v[44:47], v3 offset:7168
    ds_read_b128 v[48:51], v4 offset:0
    ds_read_b128 v[52:55], v4 offset:1024
    ds_read_b128 v[56:59], v4 offset:2048
    ds_read_b128 v[60:63], v4 offset:3072
    ds_read_b128 v[64:67], v4 offset:4096
    ds_read_b128 v[68:71], v4 offset:5120
    ds_read_b128 v[72:75], v4 offset:6144
    ds_read_b128 v[76:79], v4 offset:7168
    s_lshl_b32 s77, s72, 4
    v_add_u32 v6, s77, v14
    v_mul_u32_u24 v7, 3277, v6
    v_lshrrev_b32 v7, 16, v7
    v_mul_u32_u24 v8, 20, v7
    v_sub_u32 v8, v6, v8
    v_cmp_le_u32 vcc, 10, v8
    s_nop 1
    v_cndmask_b32 v9, 0, 1, vcc
    v_mul_u32_u24 v10, 10, v9
    v_sub_u32 v10, v8, v10
    v_lshrrev_b32 v11, 2, v10
    v_lshlrev_b32 v11, 3, v11
    v_lshl_add_u32 v11, v9, 2, v11
    v_and_b32 v12, 3, v10
    v_add_u32 v11, v11, v12
    v_sub_u32 v12, s71, v7
    v_cmp_gt_u32 vcc, 2, v12
    v_lshl_add_u32 v12, v7, 1, v12
    v_lshl_add_u32 v11, v12, 6, v11
    v_and_b32 v12, 1, v15
    v_lshl_add_u32 v11, v12, 5, v11
    v_lshlrev_b32 v11, 5, v11
    v_lshrrev_b32 v12, 1, v15
    v_lshl_add_u32 v11, v12, 4, v11
    v_cndmask_b32 v11, v13, v11, vcc
    s_waitcnt lgkmcnt(0)
    v_mfma_f32_16x16x32_bf16 v[80:83], v[16:19], v[48:51], 0
    v_mfma_f32_16x16x32_bf16 v[80:83], v[20:23], v[52:55], v[80:83]
    v_mfma_f32_16x16x32_bf16 v[80:83], v[24:27], v[56:59], v[80:83]
    v_mfma_f32_16x16x32_bf16 v[80:83], v[28:31], v[60:63], v[80:83]
    v_mfma_f32_16x16x32_bf16 v[80:83], v[32:35], v[64:67], v[80:83]
    v_mfma_f32_16x16x32_bf16 v[80:83], v[36:39], v[68:71], v[80:83]
    v_mfma_f32_16x16x32_bf16 v[80:83], v[40:43], v[72:75], v[80:83]
    v_mfma_f32_16x16x32_bf16 v[80:83], v[44:47], v[76:79], v[80:83]
    s_nop 7
    buffer_store_dwordx4 v[80:83], v11, s[48:51], s74 offen sc1
    s_nop 1
K1_KVJ_DONE:
    s_waitcnt vmcnt(0)
    s_barrier
    s_endpgm
K1_PACK:
    s_sub_u32 s60, s29, 4
    s_lshl_b32 s60, s60, 2
    s_add_u32 s60, s60, s52
    s_mul_i32 s60, s60, 12
    s_add_u32 s60, s60, s24
    s_cmp_lg_u32 s60, 0
    s_cbranch_scc1 K1_PK_NOTAG
    s_mov_b32 s56, s20
    s_and_b32 s57, s21, 0xffff
    s_mov_b32 s58, 256
    s_mov_b32 s59, 0x20000
    s_memrealtime s[72:73]
    s_waitcnt lgkmcnt(0)
    s_or_b32 s72, s72, 1
    v_mov_b32 v2, s72
    s_mov_b64 exec, 1
    buffer_store_dword v2, off, s[56:59], 0 sc0 sc1
    s_mov_b64 exec, -1
K1_PK_NOTAG:
    s_mov_b32 s36, s16
    s_and_b32 s37, s17, 0xffff
    s_mov_b32 s38, 2211840
    s_mov_b32 s39, 0x20000
    s_mov_b32 s40, s8
    s_and_b32 s41, s9, 0xffff
    s_mov_b32 s42, 819200
    s_mov_b32 s43, 0x20000
    s_mul_i32 s61, s24, 10240
    v_add_u32 v2, 0, v0
    v_mul_u32_u24 v20, 3277, v2
    v_lshrrev_b32 v20, 16, v20
    v_mul_u32_u24 v3, 20, v20
    v_sub_u32 v3, v2, v3
    v_lshlrev_b32 v30, 4, v3
    v_add_u32 v2, 64, v0
    v_mul_u32_u24 v21, 3277, v2
    v_lshrrev_b32 v21, 16, v21
    v_mul_u32_u24 v3, 20, v21
    v_sub_u32 v3, v2, v3
    v_lshlrev_b32 v31, 4, v3
    v_add_u32 v2, 128, v0
    v_mul_u32_u24 v22, 3277, v2
    v_lshrrev_b32 v22, 16, v22
    v_mul_u32_u24 v3, 20, v22
    v_sub_u32 v3, v2, v3
    v_lshlrev_b32 v32, 4, v3
    v_add_u32 v2, 192, v0
    v_mul_u32_u24 v23, 3277, v2
    v_lshrrev_b32 v23, 16, v23
    v_mul_u32_u24 v3, 20, v23
    v_sub_u32 v3, v2, v3
    v_lshlrev_b32 v33, 4, v3
    v_add_u32 v2, 256, v0
    v_mul_u32_u24 v24, 3277, v2
    v_lshrrev_b32 v24, 16, v24
    v_mul_u32_u24 v3, 20, v24
    v_sub_u32 v3, v2, v3
    v_lshlrev_b32 v34, 4, v3
    v_add_u32 v2, 320, v0
    v_mul_u32_u24 v25, 3277, v2
    v_lshrrev_b32 v25, 16, v25
    v_mul_u32_u24 v3, 20, v25
    v_sub_u32 v3, v2, v3
    v_lshlrev_b32 v35, 4, v3
    v_add_u32 v2, 384, v0
    v_mul_u32_u24 v26, 3277, v2
    v_lshrrev_b32 v26, 16, v26
    v_mul_u32_u24 v3, 20, v26
    v_sub_u32 v3, v2, v3
    v_lshlrev_b32 v36, 4, v3
    v_add_u32 v2, 448, v0
    v_mul_u32_u24 v27, 3277, v2
    v_lshrrev_b32 v27, 16, v27
    v_mul_u32_u24 v3, 20, v27
    v_sub_u32 v3, v2, v3
    v_lshlrev_b32 v37, 4, v3
    v_add_u32 v2, 512, v0
    v_mul_u32_u24 v28, 3277, v2
    v_lshrrev_b32 v28, 16, v28
    v_mul_u32_u24 v3, 20, v28
    v_sub_u32 v3, v2, v3
    v_lshlrev_b32 v38, 4, v3
    v_add_u32 v2, 576, v0
    v_mul_u32_u24 v29, 3277, v2
    v_lshrrev_b32 v29, 16, v29
    v_mul_u32_u24 v3, 20, v29
    v_sub_u32 v3, v2, v3
    v_lshlrev_b32 v39, 4, v3
    v_lshrrev_b32 v2, 4, v0
    v_bfe_u32 v3, v0, 2, 2
    v_lshl_add_u32 v2, v2, 3, v3
    v_mul_u32_u24 v2, 320, v2
    v_and_b32 v3, 3, v0
    v_lshl_add_u32 v2, v3, 3, v2
    v_add_u32 v10, s61, v2
    v_lshlrev_b32 v11, 4, v0
    s_cmp_ge_u32 s60, 64
    s_cbranch_scc1 K1_PK_NOPOI
    v_mov_b32 v12, -1
    v_mov_b32 v13, -1
    v_mov_b32 v14, -1
    v_mov_b32 v15, -1
    s_lshl_b32 s62, s60, 10
    s_add_u32 s62, s62, 13778944
    buffer_store_dwordx4 v[12:15], v11, s[48:51], s62 offen sc0 sc1
K1_PK_NOPOI:
    s_mov_b32 s70, 0
K1_PK_LOOP:
    s_lshr_b32 s62, s60, 2
    s_and_b32 s63, s60, 3
    s_mul_i32 s64, s63, 320
    s_cmp_ge_u32 s62, 54
    s_cbranch_scc1 K1_PK_O
    s_mul_i32 s65, s62, 40960
    s_add_u32 s64, s64, s65
    s_mul_i32 s65, s62, 86
    s_lshr_b32 s65, s65, 8
    s_mul_i32 s65, s65, 3
    s_sub_u32 s65, s62, s65
    s_cmp_eq_u32 s65, 1
    s_cselect_b64 s[68:69], -1, 0
    v_and_b32 v2, 3, v20
    v_lshrrev_b32 v3, 3, v20
    v_lshl_add_u32 v2, v3, 2, v2
    v_bfe_u32 v3, v20, 2, 1
    v_lshl_add_u32 v2, v3, 4, v2
    v_cndmask_b32 v2, v2, v20, s[68:69]
    v_mul_u32_u24 v2, 1280, v2
    v_add_u32 v2, v2, v30
    s_add_u32 m0, s61, 0
    s_nop 0
    buffer_load_dwordx4 v2, s[36:39], s64 offen lds
    v_and_b32 v2, 3, v21
    v_lshrrev_b32 v3, 3, v21
    v_lshl_add_u32 v2, v3, 2, v2
    v_bfe_u32 v3, v21, 2, 1
    v_lshl_add_u32 v2, v3, 4, v2
    v_cndmask_b32 v2, v2, v21, s[68:69]
    v_mul_u32_u24 v2, 1280, v2
    v_add_u32 v2, v2, v31
    s_add_u32 m0, s61, 1024
    s_nop 0
    buffer_load_dwordx4 v2, s[36:39], s64 offen lds
    v_and_b32 v2, 3, v22
    v_lshrrev_b32 v3, 3, v22
    v_lshl_add_u32 v2, v3, 2, v2
    v_bfe_u32 v3, v22, 2, 1
    v_lshl_add_u32 v2, v3, 4, v2
    v_cndmask_b32 v2, v2, v22, s[68:69]
    v_mul_u32_u24 v2, 1280, v2
    v_add_u32 v2, v2, v32
    s_add_u32 m0, s61, 2048
    s_nop 0
    buffer_load_dwordx4 v2, s[36:39], s64 offen lds
    v_and_b32 v2, 3, v23
    v_lshrrev_b32 v3, 3, v23
    v_lshl_add_u32 v2, v3, 2, v2
    v_bfe_u32 v3, v23, 2, 1
    v_lshl_add_u32 v2, v3, 4, v2
    v_cndmask_b32 v2, v2, v23, s[68:69]
    v_mul_u32_u24 v2, 1280, v2
    v_add_u32 v2, v2, v33
    s_add_u32 m0, s61, 3072
    s_nop 0
    buffer_load_dwordx4 v2, s[36:39], s64 offen lds
    v_and_b32 v2, 3, v24
    v_lshrrev_b32 v3, 3, v24
    v_lshl_add_u32 v2, v3, 2, v2
    v_bfe_u32 v3, v24, 2, 1
    v_lshl_add_u32 v2, v3, 4, v2
    v_cndmask_b32 v2, v2, v24, s[68:69]
    v_mul_u32_u24 v2, 1280, v2
    v_add_u32 v2, v2, v34
    s_add_u32 m0, s61, 4096
    s_nop 0
    buffer_load_dwordx4 v2, s[36:39], s64 offen lds
    v_and_b32 v2, 3, v25
    v_lshrrev_b32 v3, 3, v25
    v_lshl_add_u32 v2, v3, 2, v2
    v_bfe_u32 v3, v25, 2, 1
    v_lshl_add_u32 v2, v3, 4, v2
    v_cndmask_b32 v2, v2, v25, s[68:69]
    v_mul_u32_u24 v2, 1280, v2
    v_add_u32 v2, v2, v35
    s_add_u32 m0, s61, 5120
    s_nop 0
    buffer_load_dwordx4 v2, s[36:39], s64 offen lds
    v_and_b32 v2, 3, v26
    v_lshrrev_b32 v3, 3, v26
    v_lshl_add_u32 v2, v3, 2, v2
    v_bfe_u32 v3, v26, 2, 1
    v_lshl_add_u32 v2, v3, 4, v2
    v_cndmask_b32 v2, v2, v26, s[68:69]
    v_mul_u32_u24 v2, 1280, v2
    v_add_u32 v2, v2, v36
    s_add_u32 m0, s61, 6144
    s_nop 0
    buffer_load_dwordx4 v2, s[36:39], s64 offen lds
    v_and_b32 v2, 3, v27
    v_lshrrev_b32 v3, 3, v27
    v_lshl_add_u32 v2, v3, 2, v2
    v_bfe_u32 v3, v27, 2, 1
    v_lshl_add_u32 v2, v3, 4, v2
    v_cndmask_b32 v2, v2, v27, s[68:69]
    v_mul_u32_u24 v2, 1280, v2
    v_add_u32 v2, v2, v37
    s_add_u32 m0, s61, 7168
    s_nop 0
    buffer_load_dwordx4 v2, s[36:39], s64 offen lds
    v_and_b32 v2, 3, v28
    v_lshrrev_b32 v3, 3, v28
    v_lshl_add_u32 v2, v3, 2, v2
    v_bfe_u32 v3, v28, 2, 1
    v_lshl_add_u32 v2, v3, 4, v2
    v_cndmask_b32 v2, v2, v28, s[68:69]
    v_mul_u32_u24 v2, 1280, v2
    v_add_u32 v2, v2, v38
    s_add_u32 m0, s61, 8192
    s_nop 0
    buffer_load_dwordx4 v2, s[36:39], s64 offen lds
    v_and_b32 v2, 3, v29
    v_lshrrev_b32 v3, 3, v29
    v_lshl_add_u32 v2, v3, 2, v2
    v_bfe_u32 v3, v29, 2, 1
    v_lshl_add_u32 v2, v3, 4, v2
    v_cndmask_b32 v2, v2, v29, s[68:69]
    v_mul_u32_u24 v2, 1280, v2
    v_add_u32 v2, v2, v39
    s_add_u32 m0, s61, 9216
    s_nop 0
    buffer_load_dwordx4 v2, s[36:39], s64 offen lds
    s_branch K1_PK_GO
K1_PK_O:
    s_sub_u32 s65, s62, 54
    s_mul_i32 s66, s65, 52
    s_lshr_b32 s66, s66, 8
    s_mul_i32 s67, s66, 5
    s_sub_u32 s67, s65, s67
    s_lshl_b32 s67, s67, 4
    s_mul_i32 s66, s66, 204800
    s_add_u32 s64, s64, s66
    v_and_b32 v2, 15, v20
    v_add_u32 v2, s67, v2
    v_mul_u32_u24 v3, 6554, v2
    v_lshrrev_b32 v3, 16, v3
    v_mul_u32_u24 v4, 10, v3
    v_sub_u32 v4, v2, v4
    v_mul_u32_u24 v3, 20, v3
    v_add_u32 v3, v3, v4
    v_lshrrev_b32 v4, 4, v20
    v_mul_u32_u24 v4, 10, v4
    v_add_u32 v3, v3, v4
    v_mul_u32_u24 v2, 1280, v3
    v_add_u32 v2, v2, v30
    s_add_u32 m0, s61, 0
    s_nop 0
    buffer_load_dwordx4 v2, s[40:43], s64 offen lds
    v_and_b32 v2, 15, v21
    v_add_u32 v2, s67, v2
    v_mul_u32_u24 v3, 6554, v2
    v_lshrrev_b32 v3, 16, v3
    v_mul_u32_u24 v4, 10, v3
    v_sub_u32 v4, v2, v4
    v_mul_u32_u24 v3, 20, v3
    v_add_u32 v3, v3, v4
    v_lshrrev_b32 v4, 4, v21
    v_mul_u32_u24 v4, 10, v4
    v_add_u32 v3, v3, v4
    v_mul_u32_u24 v2, 1280, v3
    v_add_u32 v2, v2, v31
    s_add_u32 m0, s61, 1024
    s_nop 0
    buffer_load_dwordx4 v2, s[40:43], s64 offen lds
    v_and_b32 v2, 15, v22
    v_add_u32 v2, s67, v2
    v_mul_u32_u24 v3, 6554, v2
    v_lshrrev_b32 v3, 16, v3
    v_mul_u32_u24 v4, 10, v3
    v_sub_u32 v4, v2, v4
    v_mul_u32_u24 v3, 20, v3
    v_add_u32 v3, v3, v4
    v_lshrrev_b32 v4, 4, v22
    v_mul_u32_u24 v4, 10, v4
    v_add_u32 v3, v3, v4
    v_mul_u32_u24 v2, 1280, v3
    v_add_u32 v2, v2, v32
    s_add_u32 m0, s61, 2048
    s_nop 0
    buffer_load_dwordx4 v2, s[40:43], s64 offen lds
    v_and_b32 v2, 15, v23
    v_add_u32 v2, s67, v2
    v_mul_u32_u24 v3, 6554, v2
    v_lshrrev_b32 v3, 16, v3
    v_mul_u32_u24 v4, 10, v3
    v_sub_u32 v4, v2, v4
    v_mul_u32_u24 v3, 20, v3
    v_add_u32 v3, v3, v4
    v_lshrrev_b32 v4, 4, v23
    v_mul_u32_u24 v4, 10, v4
    v_add_u32 v3, v3, v4
    v_mul_u32_u24 v2, 1280, v3
    v_add_u32 v2, v2, v33
    s_add_u32 m0, s61, 3072
    s_nop 0
    buffer_load_dwordx4 v2, s[40:43], s64 offen lds
    v_and_b32 v2, 15, v24
    v_add_u32 v2, s67, v2
    v_mul_u32_u24 v3, 6554, v2
    v_lshrrev_b32 v3, 16, v3
    v_mul_u32_u24 v4, 10, v3
    v_sub_u32 v4, v2, v4
    v_mul_u32_u24 v3, 20, v3
    v_add_u32 v3, v3, v4
    v_lshrrev_b32 v4, 4, v24
    v_mul_u32_u24 v4, 10, v4
    v_add_u32 v3, v3, v4
    v_mul_u32_u24 v2, 1280, v3
    v_add_u32 v2, v2, v34
    s_add_u32 m0, s61, 4096
    s_nop 0
    buffer_load_dwordx4 v2, s[40:43], s64 offen lds
    v_and_b32 v2, 15, v25
    v_add_u32 v2, s67, v2
    v_mul_u32_u24 v3, 6554, v2
    v_lshrrev_b32 v3, 16, v3
    v_mul_u32_u24 v4, 10, v3
    v_sub_u32 v4, v2, v4
    v_mul_u32_u24 v3, 20, v3
    v_add_u32 v3, v3, v4
    v_lshrrev_b32 v4, 4, v25
    v_mul_u32_u24 v4, 10, v4
    v_add_u32 v3, v3, v4
    v_mul_u32_u24 v2, 1280, v3
    v_add_u32 v2, v2, v35
    s_add_u32 m0, s61, 5120
    s_nop 0
    buffer_load_dwordx4 v2, s[40:43], s64 offen lds
    v_and_b32 v2, 15, v26
    v_add_u32 v2, s67, v2
    v_mul_u32_u24 v3, 6554, v2
    v_lshrrev_b32 v3, 16, v3
    v_mul_u32_u24 v4, 10, v3
    v_sub_u32 v4, v2, v4
    v_mul_u32_u24 v3, 20, v3
    v_add_u32 v3, v3, v4
    v_lshrrev_b32 v4, 4, v26
    v_mul_u32_u24 v4, 10, v4
    v_add_u32 v3, v3, v4
    v_mul_u32_u24 v2, 1280, v3
    v_add_u32 v2, v2, v36
    s_add_u32 m0, s61, 6144
    s_nop 0
    buffer_load_dwordx4 v2, s[40:43], s64 offen lds
    v_and_b32 v2, 15, v27
    v_add_u32 v2, s67, v2
    v_mul_u32_u24 v3, 6554, v2
    v_lshrrev_b32 v3, 16, v3
    v_mul_u32_u24 v4, 10, v3
    v_sub_u32 v4, v2, v4
    v_mul_u32_u24 v3, 20, v3
    v_add_u32 v3, v3, v4
    v_lshrrev_b32 v4, 4, v27
    v_mul_u32_u24 v4, 10, v4
    v_add_u32 v3, v3, v4
    v_mul_u32_u24 v2, 1280, v3
    v_add_u32 v2, v2, v37
    s_add_u32 m0, s61, 7168
    s_nop 0
    buffer_load_dwordx4 v2, s[40:43], s64 offen lds
    v_and_b32 v2, 15, v28
    v_add_u32 v2, s67, v2
    v_mul_u32_u24 v3, 6554, v2
    v_lshrrev_b32 v3, 16, v3
    v_mul_u32_u24 v4, 10, v3
    v_sub_u32 v4, v2, v4
    v_mul_u32_u24 v3, 20, v3
    v_add_u32 v3, v3, v4
    v_lshrrev_b32 v4, 4, v28
    v_mul_u32_u24 v4, 10, v4
    v_add_u32 v3, v3, v4
    v_mul_u32_u24 v2, 1280, v3
    v_add_u32 v2, v2, v38
    s_add_u32 m0, s61, 8192
    s_nop 0
    buffer_load_dwordx4 v2, s[40:43], s64 offen lds
    v_and_b32 v2, 15, v29
    v_add_u32 v2, s67, v2
    v_mul_u32_u24 v3, 6554, v2
    v_lshrrev_b32 v3, 16, v3
    v_mul_u32_u24 v4, 10, v3
    v_sub_u32 v4, v2, v4
    v_mul_u32_u24 v3, 20, v3
    v_add_u32 v3, v3, v4
    v_lshrrev_b32 v4, 4, v29
    v_mul_u32_u24 v4, 10, v4
    v_add_u32 v3, v3, v4
    v_mul_u32_u24 v2, 1280, v3
    v_add_u32 v2, v2, v39
    s_add_u32 m0, s61, 9216
    s_nop 0
    buffer_load_dwordx4 v2, s[40:43], s64 offen lds
K1_PK_GO:
    s_lshl_b32 s65, s63, 1
    s_mul_i32 s65, s65, 74
    s_add_u32 s65, s65, s62
    s_mul_i32 s65, s65, 5120
    s_add_u32 s65, s65, 9699328
    s_cmp_eq_u32 s70, 1
    s_cbranch_scc1 K1_PK_SECOND
    s_waitcnt vmcnt(0)
    ds_read_b64_tr_b16 v[40:41], v10 offset:0
    ds_read_b64_tr_b16 v[42:43], v10 offset:1280
    ds_read_b64_tr_b16 v[44:45], v10 offset:32
    ds_read_b64_tr_b16 v[46:47], v10 offset:1312
    ds_read_b64_tr_b16 v[48:49], v10 offset:64
    ds_read_b64_tr_b16 v[50:51], v10 offset:1344
    ds_read_b64_tr_b16 v[52:53], v10 offset:96
    ds_read_b64_tr_b16 v[54:55], v10 offset:1376
    ds_read_b64_tr_b16 v[56:57], v10 offset:128
    ds_read_b64_tr_b16 v[58:59], v10 offset:1408
    ds_read_b64_tr_b16 v[60:61], v10 offset:160
    ds_read_b64_tr_b16 v[62:63], v10 offset:1440
    ds_read_b64_tr_b16 v[64:65], v10 offset:192
    ds_read_b64_tr_b16 v[66:67], v10 offset:1472
    ds_read_b64_tr_b16 v[68:69], v10 offset:224
    ds_read_b64_tr_b16 v[70:71], v10 offset:1504
    ds_read_b64_tr_b16 v[72:73], v10 offset:256
    ds_read_b64_tr_b16 v[74:75], v10 offset:1536
    ds_read_b64_tr_b16 v[76:77], v10 offset:288
    ds_read_b64_tr_b16 v[78:79], v10 offset:1568
    s_mov_b32 s71, s65
    s_mov_b32 s70, 1
    s_add_u32 s60, s60, 192
    s_waitcnt lgkmcnt(0)
    s_cmp_lt_u32 s60, 296
    s_cbranch_scc1 K1_PK_LOOP
    s_add_u32 s66, s71, 0
    buffer_store_dwordx4 v[40:43], v11, s[48:51], s66 offen sc1
    s_add_u32 s66, s71, 1024
    buffer_store_dwordx4 v[44:47], v11, s[48:51], s66 offen sc1
    s_add_u32 s66, s71, 2048
    buffer_store_dwordx4 v[48:51], v11, s[48:51], s66 offen sc1
    s_add_u32 s66, s71, 3072
    buffer_store_dwordx4 v[52:55], v11, s[48:51], s66 offen sc1
    s_add_u32 s66, s71, 4096
    buffer_store_dwordx4 v[56:59], v11, s[48:51], s66 offen sc1
    s_add_u32 s66, s71, 378880
    buffer_store_dwordx4 v[60:63], v11, s[48:51], s66 offen sc1
    s_add_u32 s66, s71, 379904
    buffer_store_dwordx4 v[64:67], v11, s[48:51], s66 offen sc1
    s_add_u32 s66, s71, 380928
    buffer_store_dwordx4 v[68:71], v11, s[48:51], s66 offen sc1
    s_add_u32 s66, s71, 381952
    buffer_store_dwordx4 v[72:75], v11, s[48:51], s66 offen sc1
    s_add_u32 s66, s71, 382976
    buffer_store_dwordx4 v[76:79], v11, s[48:51], s66 offen sc1
    s_branch K1_PK_FIN
K1_PK_SECOND:
    s_add_u32 s66, s71, 0
    buffer_store_dwordx4 v[40:43], v11, s[48:51], s66 offen sc1
    s_add_u32 s66, s71, 1024
    buffer_store_dwordx4 v[44:47], v11, s[48:51], s66 offen sc1
    s_add_u32 s66, s71, 2048
    buffer_store_dwordx4 v[48:51], v11, s[48:51], s66 offen sc1
    s_add_u32 s66, s71, 3072
    buffer_store_dwordx4 v[52:55], v11, s[48:51], s66 offen sc1
    s_add_u32 s66, s71, 4096
    buffer_store_dwordx4 v[56:59], v11, s[48:51], s66 offen sc1
    s_add_u32 s66, s71, 378880
    buffer_store_dwordx4 v[60:63], v11, s[48:51], s66 offen sc1
    s_add_u32 s66, s71, 379904
    buffer_store_dwordx4 v[64:67], v11, s[48:51], s66 offen sc1
    s_add_u32 s66, s71, 380928
    buffer_store_dwordx4 v[68:71], v11, s[48:51], s66 offen sc1
    s_add_u32 s66, s71, 381952
    buffer_store_dwordx4 v[72:75], v11, s[48:51], s66 offen sc1
    s_add_u32 s66, s71, 382976
    buffer_store_dwordx4 v[76:79], v11, s[48:51], s66 offen sc1
    s_waitcnt vmcnt(10)
    ds_read_b64_tr_b16 v[80:81], v10 offset:0
    ds_read_b64_tr_b16 v[82:83], v10 offset:1280
    ds_read_b64_tr_b16 v[84:85], v10 offset:32
    ds_read_b64_tr_b16 v[86:87], v10 offset:1312
    ds_read_b64_tr_b16 v[88:89], v10 offset:64
    ds_read_b64_tr_b16 v[90:91], v10 offset:1344
    ds_read_b64_tr_b16 v[92:93], v10 offset:96
    ds_read_b64_tr_b16 v[94:95], v10 offset:1376
    ds_read_b64_tr_b16 v[96:97], v10 offset:128
    ds_read_b64_tr_b16 v[98:99], v10 offset:1408
    ds_read_b64_tr_b16 v[100:101], v10 offset:160
    ds_read_b64_tr_b16 v[102:103], v10 offset:1440
    ds_read_b64_tr_b16 v[104:105], v10 offset:192
    ds_read_b64_tr_b16 v[106:107], v10 offset:1472
    ds_read_b64_tr_b16 v[108:109], v10 offset:224
    ds_read_b64_tr_b16 v[110:111], v10 offset:1504
    ds_read_b64_tr_b16 v[112:113], v10 offset:256
    ds_read_b64_tr_b16 v[114:115], v10 offset:1536
    ds_read_b64_tr_b16 v[116:117], v10 offset:288
    ds_read_b64_tr_b16 v[118:119], v10 offset:1568
    s_waitcnt lgkmcnt(0)
    s_add_u32 s66, s65, 0
    buffer_store_dwordx4 v[80:83], v11, s[48:51], s66 offen sc1
    s_add_u32 s66, s65, 1024
    buffer_store_dwordx4 v[84:87], v11, s[48:51], s66 offen sc1
    s_add_u32 s66, s65, 2048
    buffer_store_dwordx4 v[88:91], v11, s[48:51], s66 offen sc1
    s_add_u32 s66, s65, 3072
    buffer_store_dwordx4 v[92:95], v11, s[48:51], s66 offen sc1
    s_add_u32 s66, s65, 4096
    buffer_store_dwordx4 v[96:99], v11, s[48:51], s66 offen sc1
    s_add_u32 s66, s65, 378880
    buffer_store_dwordx4 v[100:103], v11, s[48:51], s66 offen sc1
    s_add_u32 s66, s65, 379904
    buffer_store_dwordx4 v[104:107], v11, s[48:51], s66 offen sc1
    s_add_u32 s66, s65, 380928
    buffer_store_dwordx4 v[108:111], v11, s[48:51], s66 offen sc1
    s_add_u32 s66, s65, 381952
    buffer_store_dwordx4 v[112:115], v11, s[48:51], s66 offen sc1
    s_add_u32 s66, s65, 382976
    buffer_store_dwordx4 v[116:119], v11, s[48:51], s66 offen sc1
K1_PK_FIN:
    s_mov_b32 s56, s20
    s_and_b32 s57, s21, 0xffff
    s_mov_b32 s58, 256
    s_mov_b32 s59, 0x20000
    s_waitcnt vmcnt(0)
    s_barrier
    s_cmp_lt_u32 s24, 8
    s_cbranch_scc1 K1_END
    s_mov_b32 s73, 0
K1_PK_TAG:
    buffer_load_dword v13, off, s[56:59], 0 sc1
    s_waitcnt vmcnt(0)
    v_readfirstlane_b32 s78, v13
    s_add_u32 s73, s73, 1
    s_cmp_gt_u32 s73, 200000
    s_cbranch_scc1 K1_PK_TAGOK
    s_cmp_eq_u32 s78, 0
    s_cbranch_scc1 K1_PK_TAG
K1_PK_TAGOK:
    s_sub_u32 s60, s24, 8
    s_cmp_lg_u32 s60, 0
    s_cbranch_scc1 K1_PK_NOFLAG
    s_sub_u32 s72, s29, 4
    s_lshl_b32 s72, s72, 2
    s_add_u32 s72, s72, s52
    s_lshl_b32 s72, s72, 7
    s_add_u32 s72, s72, 14237696
    s_mov_b64 exec, 1
    buffer_store_dword v13, off, s[48:51], s72 sc0 sc1
    s_mov_b64 exec, -1
K1_PK_NOFLAG:
    s_and_b32 s72, s2, 7
    s_lshr_b32 s73, s2, 3
    s_and_b32 s74, s72, 3
    s_lshl_b32 s74, s74, 3
    s_and_b32 s75, s73, 7
    s_add_u32 s61, s74, s75
    s_lshr_b32 s74, s72, 2
    s_lshl_b32 s74, s74, 2
    s_lshr_b32 s75, s73, 3
    s_add_u32 s62, s74, s75
    v_lshlrev_b32 v6, 4, v0
    s_xor_b32 s72, s60, 0
    s_lshl_b32 s72, s72, 10
    v_add_u32 v2, s72, v6
    s_xor_b32 s72, s60, 1
    s_lshl_b32 s72, s72, 10
    v_add_u32 v3, s72, v6
    s_xor_b32 s72, s60, 2
    s_lshl_b32 s72, s72, 10
    v_add_u32 v4, s72, v6
    s_xor_b32 s72, s60, 3
    s_lshl_b32 s72, s72, 10
    v_add_u32 v5, s72, v6
    s_and_b32 s72, s60, 1
    s_lshl_b32 s72, s72, 8
    v_xor_b32 v11, s72, v6
    s_lshr_b32 s72, s60, 1
    s_lshl_b32 s73, s72, 10
    v_add_u32 v7, s73, v11
    s_xor_b32 s73, s73, 1024
    v_add_u32 v8, s73, v11
    s_mul_i32 s63, s61, 221184
    s_mul_i32 s64, s62, 378880
    s_add_u32 s64, s64, 9699328
    s_mul_i32 s72, s60, 25600
    s_add_u32 s67, s64, s72
    s_add_u32 s67, s67, 276480
    s_and_b32 s72, s60, 1
    s_add_u32 s72, s72, 52
    s_lshl_b32 s73, s72, 12
    s_add_u32 s68, s63, s73
    s_mul_i32 s73, s72, 5120
    s_add_u32 s69, s64, s73
    s_mul_i32 s72, s60, 53248
    s_add_u32 s63, s63, s72
    s_mul_i32 s72, s60, 66560
    s_add_u32 s64, s64, s72
    s_mul_i32 s65, s61, 81920
    s_mul_i32 s72, s60, 20480
    s_add_u32 s65, s65, s72
    s_add_u32 s65, s65, 7077888
    s_lshl_b32 s66, s60, 14
    s_add_u32 s66, s66, 13778944
    v_and_b32 v11, 15, v0
    v_mul_u32_u24 v9, 1280, v11
    v_lshrrev_b32 v11, 4, v0
    v_lshl_add_u32 v9, v11, 3, v9
    s_lshl_b32 s72, s61, 2
    s_add_u32 s72, s72, s60
    s_mul_i32 s72, s72, 20480
    s_mul_i32 s73, s62, 160
    s_add_u32 s70, s72, s73
    s_mul_i32 s71, s60, 39936
    v_add_u32 v10, s71, v6
    s_mov_b32 s36, s18
    s_and_b32 s37, s19, 0xffff
    s_mov_b32 s38, 2621440
    s_mov_b32 s39, 0x20000
    v_add_u32 v2, s71, v2
    v_add_u32 v3, s71, v3
    v_add_u32 v4, s71, v4
    v_add_u32 v5, s71, v5
    v_add_u32 v7, s71, v7
    v_add_u32 v8, s71, v8
    s_mov_b32 s79, 1
    s_branch P2_ENTRY
K1_END:
    s_endpgm
.section .rodata,"a"
.p2align 6
.amdhsa_kernel parallel_sum__linear_attn_block__geglu_ffn__prompt_kernel
  .amdhsa_next_free_vgpr 168
  .amdhsa_next_free_sgpr 102
  .amdhsa_accum_offset 168
  .amdhsa_group_segment_fixed_size 0
  .amdhsa_kernarg_size 80
  .amdhsa_user_sgpr_count 2
  .amdhsa_user_sgpr_kernarg_segment_ptr 1
  .amdhsa_system_sgpr_workgroup_id_x 1
.end_amdhsa_kernel
```
